```python
import torch

def _softmax(x, axis=-1):
    return torch.softmax(x, dim=axis)
def _gelu(x):
    return torch.nn.functional.gelu(x, approximate="tanh")
def _silu(x):
    return torch.nn.functional.silu(x)
def _sigmoid(x):
    return torch.sigmoid(x)
def _layernorm(x, axis=-1, eps=1e-5):
    m = x.mean(dim=axis, keepdim=True)
    v = x.var(dim=axis, keepdim=True, unbiased=False)
    return (x - m) / torch.sqrt(v + eps)
def _scatter_add(tgt, idx, src, axis=0):
    return tgt.clone().index_add_(axis, idx, src)
def _segment_sum(src, seg, n):
    out = torch.zeros((n,) + src.shape[1:], dtype=src.dtype)
    return out.index_add_(0, seg, src)
def _pad(x, pw):
    flat = tuple(v for pair in reversed(pw) for v in pair)
    return torch.nn.functional.pad(x, flat)

kernel_name = 'sequential_preLN__mha_block_cached__glu_gated_glu__decode'

def setup_inputs():

    _w = (lambda a: (lambda t: t.to(torch.bfloat16) if t.is_floating_point() else t)(torch.as_tensor(a)))
    def _A_setup():
        B, Sq, D = 4, 1, 512
        H, Sk, Dh = 32, 8192, 128
        return {
            "x": _w((lambda *s: torch.randn(*s, dtype=torch.bfloat16) * 0.05)(B, Sq, D)),
            "k_cache": _w((lambda *s: torch.randn(*s, dtype=torch.bfloat16) * 3.2)(B, H, Sk, Dh)),
            "v_cache": _w((lambda *s: torch.randn(*s, dtype=torch.bfloat16) * 0.4)(B, H, Sk, Dh)),
            "wq": _w((lambda *s: torch.randn(*s, dtype=torch.bfloat16) * 3.2)(D, H * Dh) * (D ** -0.5)),
            "wo": _w((lambda *s: torch.randn(*s, dtype=torch.bfloat16) * 0.4)(H * Dh, D) * ((H * Dh) ** -0.5)),
        }
    _A_in = _A_setup()

    def _B_setup():
        B, S, D, F = 4, 1, 512, 1792
        return {
            "x": _w((lambda *s: torch.randn(*s, dtype=torch.bfloat16) * 0.05)(B, S, D)),
            "w_gate": _w((lambda *s: torch.randn(*s, dtype=torch.bfloat16) * 0.1)(D, F)),
            "w_up": _w((lambda *s: torch.randn(*s, dtype=torch.bfloat16) * 0.05)(D, F)),
            "w_down": _w((lambda *s: torch.randn(*s, dtype=torch.bfloat16) * 0.05)(F, D)),
        }
    _B_in = _B_setup()

    return {
        "A_x": _A_in["x"],
        "A_k_cache": _A_in["k_cache"],
        "A_v_cache": _A_in["v_cache"],
        "A_wq": _A_in["wq"],
        "A_wo": _A_in["wo"],
        "B_x": _B_in["x"],
        "B_w_gate": _B_in["w_gate"],
        "B_w_up": _B_in["w_up"],
        "B_w_down": _B_in["w_down"],
    }

def reference(A_x, A_k_cache, A_v_cache, A_wq, A_wo, B_x, B_w_gate, B_w_up, B_w_down):
    def _A_ref(x, k_cache, v_cache, wq, wo):
        B, Sq, D = x.shape
        H, Dh = 32, 128
        q = (lambda x, *d: x.permute(*d))((x @ wq).reshape(B, Sq, H, Dh), 0, 2, 1, 3)
        scores = torch.einsum("bhqd,bhkd->bhqk", q, k_cache) * (Dh ** -0.5)
        p = _softmax(scores, axis=-1)
        o = torch.einsum("bhqk,bhkd->bhqd", p, v_cache)
        return (lambda x, *d: x.permute(*d))(o, 0, 2, 1, 3).reshape(B, Sq, H * Dh) @ wo

    def _B_ref(x, w_gate, w_up, w_down):
        g = torch.einsum("bsd,df->bsf", x, w_gate)
        u = torch.einsum("bsd,df->bsf", x, w_up)
        h = _sigmoid(g) * u
        return torch.einsum("bsf,fd->bsd", h, w_down)

    x = A_x
    h = x + _A_ref(_layernorm(x, axis=-1), A_k_cache, A_v_cache, A_wq, A_wo)
    h2 = h + _B_ref(_layernorm(h, axis=-1), B_w_gate, B_w_up, B_w_down)
    return h2
```

```asm
; @launch grid=(256,1,1) block=(512,1,1) lds=99072
.amdgcn_target "amdgcn-amd-amdhsa--gfx950"
.text
.globl sequential_preLN__mha_block_cached__glu_gated_glu__decode_kernel
.p2align 8
.type sequential_preLN__mha_block_cached__glu_gated_glu__decode_kernel,@function
sequential_preLN__mha_block_cached__glu_gated_glu__decode_kernel:
    s_cmp_ge_u32 s2, 256
    s_cbranch_scc1 L_end
    s_load_dwordx16 s[4:19], s[0:1], 0
    s_load_dwordx8 s[20:27], s[0:1], 64
    v_lshrrev_b32 v3, 6, v0
    v_and_b32 v1, 63, v0
    v_readfirstlane_b32 s44, v3
    v_lshlrev_b32 v2, 4, v1
    s_and_b32 s45, s2, 7
    s_lshr_b32 s46, s2, 3
    s_lshr_b32 s47, s46, 3
    s_lshl_b32 s48, s47, 3
    s_add_u32 s48, s48, s45
    s_bfe_u32 s49, s46, 0x20001
    s_and_b32 s50, s46, 1
    s_lshl_b32 s51, s49, 5
    s_add_u32 s51, s51, s48
    s_lshl_b32 s51, s51, 1
    s_add_u32 s51, s51, s50
    s_lshl_b32 s52, s51, 20
    s_mov_b32 s59, 0x3db504f3
    s_mov_b32 s60, 0x3fb8aa3b
    s_mov_b32 s61, 0xffff0000
    s_mov_b32 s62, 0x05040100
    s_mov_b32 s63, 0x07060302
    s_mov_b32 s30, 0x100000
    s_mov_b32 s31, 0x20000
    s_mov_b32 s34, 0xf00000
    s_mov_b32 s35, 0x20000
    s_mov_b32 s38, 0x800000
    s_mov_b32 s39, 0x20000
    s_mov_b32 s43, 0x20000
    v_bfe_u32 v5, v0, 4, 2
    v_and_b32 v6, 15, v0
    s_waitcnt lgkmcnt(0)
    s_add_u32 s28, s6, s52
    s_addc_u32 s29, s7, 0
    s_lshl_b32 s53, s45, 21
    s_sub_u32 s52, s52, s53
    s_add_u32 s32, s8, s52
    s_addc_u32 s33, s9, 0
    s_mov_b32 s36, s26
    s_mov_b32 s37, s27
    s_cmp_ge_u32 s44, 4
    s_cbranch_scc1 L_helper
    s_mov_b32 s100, 0
    v_mov_b32 v30, 0
    s_lshl_b32 s56, s44, 13
    s_add_u32 s57, s56, s53
    buffer_load_dwordx4 v[128:131], v2, s[28:31], s56 offen offset:0 nt
    buffer_load_dwordx4 v[132:135], v2, s[28:31], s56 offen offset:1024 nt
    buffer_load_dwordx4 v[136:139], v2, s[28:31], s56 offen offset:2048 nt
    buffer_load_dwordx4 v[140:143], v2, s[28:31], s56 offen offset:3072 nt
    s_add_u32 s56, s56, 4096
    buffer_load_dwordx4 v[144:147], v2, s[28:31], s56 offen offset:0 nt
    buffer_load_dwordx4 v[148:151], v2, s[28:31], s56 offen offset:1024 nt
    buffer_load_dwordx4 v[152:155], v2, s[28:31], s56 offen offset:2048 nt
    buffer_load_dwordx4 v[156:159], v2, s[28:31], s56 offen offset:3072 nt
    s_add_u32 s56, s56, 28672
    s_barrier
    s_waitcnt vmcnt(4)
    buffer_load_dwordx4 v[160:163], v2, s[28:31], s56 offen offset:0 nt
    buffer_load_dwordx4 v[164:167], v2, s[28:31], s56 offen offset:1024 nt
    s_waitcnt vmcnt(4)
    buffer_load_dwordx4 v[168:171], v2, s[28:31], s56 offen offset:2048 nt
    buffer_load_dwordx4 v[172:175], v2, s[28:31], s56 offen offset:3072 nt
    s_add_u32 s56, s56, 4096
    s_waitcnt vmcnt(4)
    buffer_load_dwordx4 v[176:179], v2, s[28:31], s56 offen offset:0 nt
    buffer_load_dwordx4 v[180:183], v2, s[28:31], s56 offen offset:1024 nt
    s_waitcnt vmcnt(4)
    buffer_load_dwordx4 v[184:187], v2, s[28:31], s56 offen offset:2048 nt
    buffer_load_dwordx4 v[188:191], v2, s[28:31], s56 offen offset:3072 nt
    s_add_u32 s56, s56, 28672
    s_waitcnt vmcnt(4)
    buffer_load_dwordx4 v[192:195], v2, s[28:31], s56 offen offset:0 nt
    buffer_load_dwordx4 v[196:199], v2, s[28:31], s56 offen offset:1024 nt
    s_waitcnt vmcnt(4)
    buffer_load_dwordx4 v[200:203], v2, s[28:31], s56 offen offset:2048 nt
    buffer_load_dwordx4 v[204:207], v2, s[28:31], s56 offen offset:3072 nt
    s_add_u32 s56, s56, 4096
    s_waitcnt vmcnt(4)
    buffer_load_dwordx4 v[208:211], v2, s[28:31], s56 offen offset:0 nt
    buffer_load_dwordx4 v[212:215], v2, s[28:31], s56 offen offset:1024 nt
    s_waitcnt vmcnt(4)
    buffer_load_dwordx4 v[216:219], v2, s[28:31], s56 offen offset:2048 nt
    buffer_load_dwordx4 v[220:223], v2, s[28:31], s56 offen offset:3072 nt
    s_add_u32 s56, s56, 28672
    s_waitcnt vmcnt(4)
    buffer_load_dwordx4 v[224:227], v2, s[28:31], s56 offen offset:0 nt
    buffer_load_dwordx4 v[228:231], v2, s[28:31], s56 offen offset:1024 nt
    s_waitcnt vmcnt(4)
    buffer_load_dwordx4 v[232:235], v2, s[28:31], s56 offen offset:2048 nt
    buffer_load_dwordx4 v[236:239], v2, s[28:31], s56 offen offset:3072 nt
    s_add_u32 s56, s56, 4096
    s_waitcnt vmcnt(4)
    buffer_load_dwordx4 v[240:243], v2, s[28:31], s56 offen offset:0 nt
    buffer_load_dwordx4 v[244:247], v2, s[28:31], s56 offen offset:1024 nt
    s_waitcnt vmcnt(4)
    buffer_load_dwordx4 v[248:251], v2, s[28:31], s56 offen offset:2048 nt
    buffer_load_dwordx4 v[252:255], v2, s[28:31], s56 offen offset:3072 nt
    s_add_u32 s56, s56, 28672
    s_waitcnt vmcnt(4)
    buffer_load_dwordx4 v[64:67], v2, s[28:31], s56 offen offset:0 nt
    buffer_load_dwordx4 v[68:71], v2, s[28:31], s56 offen offset:1024 nt
    s_waitcnt vmcnt(4)
    buffer_load_dwordx4 v[72:75], v2, s[28:31], s56 offen offset:2048 nt
    buffer_load_dwordx4 v[76:79], v2, s[28:31], s56 offen offset:3072 nt
    s_add_u32 s56, s56, 4096
    s_waitcnt vmcnt(4)
    buffer_load_dwordx4 v[80:83], v2, s[28:31], s56 offen offset:0 nt
    buffer_load_dwordx4 v[84:87], v2, s[28:31], s56 offen offset:1024 nt
    s_waitcnt vmcnt(4)
    buffer_load_dwordx4 v[88:91], v2, s[28:31], s56 offen offset:2048 nt
    buffer_load_dwordx4 v[92:95], v2, s[28:31], s56 offen offset:3072 nt
    s_add_u32 s56, s56, 28672
    s_waitcnt vmcnt(4)
    buffer_load_dwordx4 v[96:99], v2, s[28:31], s56 offen offset:0 nt
    buffer_load_dwordx4 v[100:103], v2, s[28:31], s56 offen offset:1024 nt
    s_waitcnt vmcnt(4)
    buffer_load_dwordx4 v[104:107], v2, s[28:31], s56 offen offset:2048 nt
    buffer_load_dwordx4 v[108:111], v2, s[28:31], s56 offen offset:3072 nt
    s_add_u32 s56, s56, 4096
    s_waitcnt vmcnt(4)
    buffer_load_dwordx4 v[112:115], v2, s[28:31], s56 offen offset:0 nt
    buffer_load_dwordx4 v[116:119], v2, s[28:31], s56 offen offset:1024 nt
    s_waitcnt vmcnt(4)
    buffer_load_dwordx4 v[120:123], v2, s[28:31], s56 offen offset:2048 nt
    buffer_load_dwordx4 v[124:127], v2, s[28:31], s56 offen offset:3072 nt
    s_add_u32 s56, s56, 28672
    s_lshl_b32 s52, s44, 7
    v_lshlrev_b32 v3, 5, v5
    v_add_u32 v3, s52, v3
    v_lshrrev_b32 v4, 2, v6
    v_lshlrev_b32 v4, 2, v4
    v_add_u32 v4, v3, v4
    v_lshlrev_b32 v7, 5, v6
    v_mov_b32 v24, 0xff800000
    s_barrier
    ds_read_b128 v[32:35], v7 offset:18432
    ds_read_b128 v[36:39], v7 offset:18448
    ds_read_b128 v[40:43], v7 offset:18944
    ds_read_b128 v[44:47], v7 offset:18960
    ds_read_b128 v[48:51], v7 offset:19456
    ds_read_b128 v[52:55], v7 offset:19472
    ds_read_b128 v[56:59], v7 offset:19968
    ds_read_b128 v[60:63], v7 offset:19984
    s_waitcnt lgkmcnt(0)
    v_add_f32 v32, v32, v40
    v_add_f32 v48, v48, v56
    v_add_f32 v33, v33, v41
    v_add_f32 v49, v49, v57
    v_add_f32 v34, v34, v42
    v_add_f32 v50, v50, v58
    v_add_f32 v35, v35, v43
    v_add_f32 v51, v51, v59
    v_add_f32 v36, v36, v44
    v_add_f32 v52, v52, v60
    v_add_f32 v37, v37, v45
    v_add_f32 v53, v53, v61
    v_add_f32 v38, v38, v46
    v_add_f32 v54, v54, v62
    v_add_f32 v39, v39, v47
    v_add_f32 v55, v55, v63
    v_add_f32 v32, v32, v48
    v_add_f32 v33, v33, v49
    v_add_f32 v34, v34, v50
    v_add_f32 v35, v35, v51
    v_add_f32 v36, v36, v52
    v_add_f32 v37, v37, v53
    v_add_f32 v38, v38, v54
    v_add_f32 v39, v39, v55
    v_cvt_pk_bf16_f32 v8, v32, v33
    v_cvt_pk_bf16_f32 v9, v34, v35
    v_cvt_pk_bf16_f32 v10, v36, v37
    v_cvt_pk_bf16_f32 v11, v38, v39
    v_mov_b32 v32, 0
    v_mov_b32 v33, 0
    v_mov_b32 v34, 0
    v_mov_b32 v35, 0
    v_mov_b32 v36, 0
    v_mov_b32 v37, 0
    v_mov_b32 v38, 0
    v_mov_b32 v39, 0
    s_waitcnt vmcnt(44)
    v_dot2_f32_bf16 v12, v128, v8, 0
    v_dot2_f32_bf16 v13, v132, v8, 0
    v_dot2_f32_bf16 v14, v136, v8, 0
    v_dot2_f32_bf16 v15, v140, v8, 0
    v_dot2_f32_bf16 v12, v129, v9, v12
    v_dot2_f32_bf16 v13, v133, v9, v13
    v_dot2_f32_bf16 v14, v137, v9, v14
    v_dot2_f32_bf16 v15, v141, v9, v15
    v_dot2_f32_bf16 v12, v130, v10, v12
    v_dot2_f32_bf16 v13, v134, v10, v13
    v_dot2_f32_bf16 v14, v138, v10, v14
    v_dot2_f32_bf16 v15, v142, v10, v15
    v_dot2_f32_bf16 v12, v131, v11, v12
    v_dot2_f32_bf16 v13, v135, v11, v13
    v_dot2_f32_bf16 v14, v139, v11, v14
    v_dot2_f32_bf16 v15, v143, v11, v15
    v_add_f32_dpp v12, v12, v12 row_ror:8 row_mask:0xf bank_mask:0xf
    v_add_f32_dpp v13, v13, v13 row_ror:8 row_mask:0xf bank_mask:0xf
    v_add_f32_dpp v14, v14, v14 row_ror:8 row_mask:0xf bank_mask:0xf
    v_add_f32_dpp v15, v15, v15 row_ror:8 row_mask:0xf bank_mask:0xf
    v_add_f32_dpp v12, v12, v12 row_ror:4 row_mask:0xf bank_mask:0xf
    v_add_f32_dpp v13, v13, v13 row_ror:4 row_mask:0xf bank_mask:0xf
    v_add_f32_dpp v14, v14, v14 row_ror:4 row_mask:0xf bank_mask:0xf
    v_add_f32_dpp v15, v15, v15 row_ror:4 row_mask:0xf bank_mask:0xf
    v_add_f32_dpp v12, v12, v12 row_ror:2 row_mask:0xf bank_mask:0xf
    v_add_f32_dpp v13, v13, v13 row_ror:2 row_mask:0xf bank_mask:0xf
    v_add_f32_dpp v14, v14, v14 row_ror:2 row_mask:0xf bank_mask:0xf
    v_add_f32_dpp v15, v15, v15 row_ror:2 row_mask:0xf bank_mask:0xf
    v_add_f32_dpp v16, v12, v12 row_ror:1 row_mask:0xf bank_mask:0x1
    s_nop 1
    v_add_f32_dpp v16, v13, v13 row_ror:1 row_mask:0xf bank_mask:0x2
    s_nop 1
    v_add_f32_dpp v16, v14, v14 row_ror:1 row_mask:0xf bank_mask:0x4
    s_nop 1
    v_add_f32_dpp v16, v15, v15 row_ror:1 row_mask:0xf bank_mask:0x8
    buffer_load_dwordx4 v[128:131], v2, s[28:31], s56 offen offset:0 nt
    buffer_load_dwordx4 v[132:135], v2, s[28:31], s56 offen offset:1024 nt
    buffer_load_dwordx4 v[136:139], v2, s[28:31], s56 offen offset:2048 nt
    buffer_load_dwordx4 v[140:143], v2, s[28:31], s56 offen offset:3072 nt
    s_add_u32 s56, s56, 4096
    s_waitcnt vmcnt(44)
    v_dot2_f32_bf16 v12, v144, v8, 0
    v_dot2_f32_bf16 v13, v148, v8, 0
    v_dot2_f32_bf16 v14, v152, v8, 0
    v_dot2_f32_bf16 v15, v156, v8, 0
    v_dot2_f32_bf16 v12, v145, v9, v12
    v_dot2_f32_bf16 v13, v149, v9, v13
    v_dot2_f32_bf16 v14, v153, v9, v14
    v_dot2_f32_bf16 v15, v157, v9, v15
    v_dot2_f32_bf16 v12, v146, v10, v12
    v_dot2_f32_bf16 v13, v150, v10, v13
    v_dot2_f32_bf16 v14, v154, v10, v14
    v_dot2_f32_bf16 v15, v158, v10, v15
    v_dot2_f32_bf16 v12, v147, v11, v12
    v_dot2_f32_bf16 v13, v151, v11, v13
    v_dot2_f32_bf16 v14, v155, v11, v14
    v_dot2_f32_bf16 v15, v159, v11, v15
    v_add_f32_dpp v12, v12, v12 row_ror:8 row_mask:0xf bank_mask:0xf
    v_add_f32_dpp v13, v13, v13 row_ror:8 row_mask:0xf bank_mask:0xf
    v_add_f32_dpp v14, v14, v14 row_ror:8 row_mask:0xf bank_mask:0xf
    v_add_f32_dpp v15, v15, v15 row_ror:8 row_mask:0xf bank_mask:0xf
    v_add_f32_dpp v12, v12, v12 row_ror:4 row_mask:0xf bank_mask:0xf
    v_add_f32_dpp v13, v13, v13 row_ror:4 row_mask:0xf bank_mask:0xf
    v_add_f32_dpp v14, v14, v14 row_ror:4 row_mask:0xf bank_mask:0xf
    v_add_f32_dpp v15, v15, v15 row_ror:4 row_mask:0xf bank_mask:0xf
    v_add_f32_dpp v12, v12, v12 row_ror:2 row_mask:0xf bank_mask:0xf
    v_add_f32_dpp v13, v13, v13 row_ror:2 row_mask:0xf bank_mask:0xf
    v_add_f32_dpp v14, v14, v14 row_ror:2 row_mask:0xf bank_mask:0xf
    v_add_f32_dpp v15, v15, v15 row_ror:2 row_mask:0xf bank_mask:0xf
    v_add_f32_dpp v17, v12, v12 row_ror:1 row_mask:0xf bank_mask:0x1
    s_nop 1
    v_add_f32_dpp v17, v13, v13 row_ror:1 row_mask:0xf bank_mask:0x2
    s_nop 1
    v_add_f32_dpp v17, v14, v14 row_ror:1 row_mask:0xf bank_mask:0x4
    s_nop 1
    v_add_f32_dpp v17, v15, v15 row_ror:1 row_mask:0xf bank_mask:0x8
    v_cvt_pk_bf16_f32 v18, v16, v17
    v_lshlrev_b32 v19, 16, v18
    v_and_b32 v20, s61, v18
    v_mul_f32 v19, s59, v19
    v_mul_f32 v20, s59, v20
    v_cvt_pk_bf16_f32 v18, v19, v20
    v_lshlrev_b32 v19, 16, v18
    v_and_b32 v20, s61, v18
    ds_write_b32 v4, v19 offset:0
    ds_write_b32 v4, v20 offset:16
    v_max3_f32 v24, v24, v19, v20
    buffer_load_dwordx4 v[144:147], v2, s[28:31], s56 offen offset:0 nt
    buffer_load_dwordx4 v[148:151], v2, s[28:31], s56 offen offset:1024 nt
    buffer_load_dwordx4 v[152:155], v2, s[28:31], s56 offen offset:2048 nt
    buffer_load_dwordx4 v[156:159], v2, s[28:31], s56 offen offset:3072 nt
    s_add_u32 s56, s56, 28672
    s_waitcnt vmcnt(44)
    v_dot2_f32_bf16 v12, v160, v8, 0
    v_dot2_f32_bf16 v13, v164, v8, 0
    v_dot2_f32_bf16 v14, v168, v8, 0
    v_dot2_f32_bf16 v15, v172, v8, 0
    v_dot2_f32_bf16 v12, v161, v9, v12
    v_dot2_f32_bf16 v13, v165, v9, v13
    v_dot2_f32_bf16 v14, v169, v9, v14
    v_dot2_f32_bf16 v15, v173, v9, v15
    v_dot2_f32_bf16 v12, v162, v10, v12
    v_dot2_f32_bf16 v13, v166, v10, v13
    v_dot2_f32_bf16 v14, v170, v10, v14
    v_dot2_f32_bf16 v15, v174, v10, v15
    v_dot2_f32_bf16 v12, v163, v11, v12
    v_dot2_f32_bf16 v13, v167, v11, v13
    v_dot2_f32_bf16 v14, v171, v11, v14
    v_dot2_f32_bf16 v15, v175, v11, v15
    v_add_f32_dpp v12, v12, v12 row_ror:8 row_mask:0xf bank_mask:0xf
    v_add_f32_dpp v13, v13, v13 row_ror:8 row_mask:0xf bank_mask:0xf
    v_add_f32_dpp v14, v14, v14 row_ror:8 row_mask:0xf bank_mask:0xf
    v_add_f32_dpp v15, v15, v15 row_ror:8 row_mask:0xf bank_mask:0xf
    v_add_f32_dpp v12, v12, v12 row_ror:4 row_mask:0xf bank_mask:0xf
    v_add_f32_dpp v13, v13, v13 row_ror:4 row_mask:0xf bank_mask:0xf
    v_add_f32_dpp v14, v14, v14 row_ror:4 row_mask:0xf bank_mask:0xf
    v_add_f32_dpp v15, v15, v15 row_ror:4 row_mask:0xf bank_mask:0xf
    v_add_f32_dpp v12, v12, v12 row_ror:2 row_mask:0xf bank_mask:0xf
    v_add_f32_dpp v13, v13, v13 row_ror:2 row_mask:0xf bank_mask:0xf
    v_add_f32_dpp v14, v14, v14 row_ror:2 row_mask:0xf bank_mask:0xf
    v_add_f32_dpp v15, v15, v15 row_ror:2 row_mask:0xf bank_mask:0xf
    v_add_f32_dpp v16, v12, v12 row_ror:1 row_mask:0xf bank_mask:0x1
    s_nop 1
    v_add_f32_dpp v16, v13, v13 row_ror:1 row_mask:0xf bank_mask:0x2
    s_nop 1
    v_add_f32_dpp v16, v14, v14 row_ror:1 row_mask:0xf bank_mask:0x4
    s_nop 1
    v_add_f32_dpp v16, v15, v15 row_ror:1 row_mask:0xf bank_mask:0x8
    buffer_load_dwordx4 v[160:163], v2, s[28:31], s56 offen offset:0 nt
    buffer_load_dwordx4 v[164:167], v2, s[28:31], s56 offen offset:1024 nt
    buffer_load_dwordx4 v[168:171], v2, s[28:31], s56 offen offset:2048 nt
    buffer_load_dwordx4 v[172:175], v2, s[28:31], s56 offen offset:3072 nt
    s_add_u32 s56, s56, 4096
    s_waitcnt vmcnt(44)
    v_dot2_f32_bf16 v12, v176, v8, 0
    v_dot2_f32_bf16 v13, v180, v8, 0
    v_dot2_f32_bf16 v14, v184, v8, 0
    v_dot2_f32_bf16 v15, v188, v8, 0
    v_dot2_f32_bf16 v12, v177, v9, v12
    v_dot2_f32_bf16 v13, v181, v9, v13
    v_dot2_f32_bf16 v14, v185, v9, v14
    v_dot2_f32_bf16 v15, v189, v9, v15
    v_dot2_f32_bf16 v12, v178, v10, v12
    v_dot2_f32_bf16 v13, v182, v10, v13
    v_dot2_f32_bf16 v14, v186, v10, v14
    v_dot2_f32_bf16 v15, v190, v10, v15
    v_dot2_f32_bf16 v12, v179, v11, v12
    v_dot2_f32_bf16 v13, v183, v11, v13
    v_dot2_f32_bf16 v14, v187, v11, v14
    v_dot2_f32_bf16 v15, v191, v11, v15
    v_add_f32_dpp v12, v12, v12 row_ror:8 row_mask:0xf bank_mask:0xf
    v_add_f32_dpp v13, v13, v13 row_ror:8 row_mask:0xf bank_mask:0xf
    v_add_f32_dpp v14, v14, v14 row_ror:8 row_mask:0xf bank_mask:0xf
    v_add_f32_dpp v15, v15, v15 row_ror:8 row_mask:0xf bank_mask:0xf
    v_add_f32_dpp v12, v12, v12 row_ror:4 row_mask:0xf bank_mask:0xf
    v_add_f32_dpp v13, v13, v13 row_ror:4 row_mask:0xf bank_mask:0xf
    v_add_f32_dpp v14, v14, v14 row_ror:4 row_mask:0xf bank_mask:0xf
    v_add_f32_dpp v15, v15, v15 row_ror:4 row_mask:0xf bank_mask:0xf
    v_add_f32_dpp v12, v12, v12 row_ror:2 row_mask:0xf bank_mask:0xf
    v_add_f32_dpp v13, v13, v13 row_ror:2 row_mask:0xf bank_mask:0xf
    v_add_f32_dpp v14, v14, v14 row_ror:2 row_mask:0xf bank_mask:0xf
    v_add_f32_dpp v15, v15, v15 row_ror:2 row_mask:0xf bank_mask:0xf
    v_add_f32_dpp v17, v12, v12 row_ror:1 row_mask:0xf bank_mask:0x1
    s_nop 1
    v_add_f32_dpp v17, v13, v13 row_ror:1 row_mask:0xf bank_mask:0x2
    s_nop 1
    v_add_f32_dpp v17, v14, v14 row_ror:1 row_mask:0xf bank_mask:0x4
    s_nop 1
    v_add_f32_dpp v17, v15, v15 row_ror:1 row_mask:0xf bank_mask:0x8
    v_cvt_pk_bf16_f32 v18, v16, v17
    v_lshlrev_b32 v19, 16, v18
    v_and_b32 v20, s61, v18
    v_mul_f32 v19, s59, v19
    v_mul_f32 v20, s59, v20
    v_cvt_pk_bf16_f32 v18, v19, v20
    v_lshlrev_b32 v19, 16, v18
    v_and_b32 v20, s61, v18
    ds_write_b32 v4, v19 offset:512
    ds_write_b32 v4, v20 offset:528
    v_max3_f32 v24, v24, v19, v20
    buffer_load_dwordx4 v[176:179], v2, s[28:31], s56 offen offset:0 nt
    buffer_load_dwordx4 v[180:183], v2, s[28:31], s56 offen offset:1024 nt
    buffer_load_dwordx4 v[184:187], v2, s[28:31], s56 offen offset:2048 nt
    buffer_load_dwordx4 v[188:191], v2, s[28:31], s56 offen offset:3072 nt
    s_add_u32 s56, s56, 28672
    s_waitcnt vmcnt(44)
    v_dot2_f32_bf16 v12, v192, v8, 0
    v_dot2_f32_bf16 v13, v196, v8, 0
    v_dot2_f32_bf16 v14, v200, v8, 0
    v_dot2_f32_bf16 v15, v204, v8, 0
    v_dot2_f32_bf16 v12, v193, v9, v12
    v_dot2_f32_bf16 v13, v197, v9, v13
    v_dot2_f32_bf16 v14, v201, v9, v14
    v_dot2_f32_bf16 v15, v205, v9, v15
    v_dot2_f32_bf16 v12, v194, v10, v12
    v_dot2_f32_bf16 v13, v198, v10, v13
    v_dot2_f32_bf16 v14, v202, v10, v14
    v_dot2_f32_bf16 v15, v206, v10, v15
    v_dot2_f32_bf16 v12, v195, v11, v12
    v_dot2_f32_bf16 v13, v199, v11, v13
    v_dot2_f32_bf16 v14, v203, v11, v14
    v_dot2_f32_bf16 v15, v207, v11, v15
    v_add_f32_dpp v12, v12, v12 row_ror:8 row_mask:0xf bank_mask:0xf
    v_add_f32_dpp v13, v13, v13 row_ror:8 row_mask:0xf bank_mask:0xf
    v_add_f32_dpp v14, v14, v14 row_ror:8 row_mask:0xf bank_mask:0xf
    v_add_f32_dpp v15, v15, v15 row_ror:8 row_mask:0xf bank_mask:0xf
    v_add_f32_dpp v12, v12, v12 row_ror:4 row_mask:0xf bank_mask:0xf
    v_add_f32_dpp v13, v13, v13 row_ror:4 row_mask:0xf bank_mask:0xf
    v_add_f32_dpp v14, v14, v14 row_ror:4 row_mask:0xf bank_mask:0xf
    v_add_f32_dpp v15, v15, v15 row_ror:4 row_mask:0xf bank_mask:0xf
    v_add_f32_dpp v12, v12, v12 row_ror:2 row_mask:0xf bank_mask:0xf
    v_add_f32_dpp v13, v13, v13 row_ror:2 row_mask:0xf bank_mask:0xf
    v_add_f32_dpp v14, v14, v14 row_ror:2 row_mask:0xf bank_mask:0xf
    v_add_f32_dpp v15, v15, v15 row_ror:2 row_mask:0xf bank_mask:0xf
    v_add_f32_dpp v16, v12, v12 row_ror:1 row_mask:0xf bank_mask:0x1
    s_nop 1
    v_add_f32_dpp v16, v13, v13 row_ror:1 row_mask:0xf bank_mask:0x2
    s_nop 1
    v_add_f32_dpp v16, v14, v14 row_ror:1 row_mask:0xf bank_mask:0x4
    s_nop 1
    v_add_f32_dpp v16, v15, v15 row_ror:1 row_mask:0xf bank_mask:0x8
    s_waitcnt vmcnt(40)
    v_dot2_f32_bf16 v12, v208, v8, 0
    v_dot2_f32_bf16 v13, v212, v8, 0
    v_dot2_f32_bf16 v14, v216, v8, 0
    v_dot2_f32_bf16 v15, v220, v8, 0
    v_dot2_f32_bf16 v12, v209, v9, v12
    v_dot2_f32_bf16 v13, v213, v9, v13
    v_dot2_f32_bf16 v14, v217, v9, v14
    v_dot2_f32_bf16 v15, v221, v9, v15
    v_dot2_f32_bf16 v12, v210, v10, v12
    v_dot2_f32_bf16 v13, v214, v10, v13
    v_dot2_f32_bf16 v14, v218, v10, v14
    v_dot2_f32_bf16 v15, v222, v10, v15
    v_dot2_f32_bf16 v12, v211, v11, v12
    v_dot2_f32_bf16 v13, v215, v11, v13
    v_dot2_f32_bf16 v14, v219, v11, v14
    v_dot2_f32_bf16 v15, v223, v11, v15
    v_add_f32_dpp v12, v12, v12 row_ror:8 row_mask:0xf bank_mask:0xf
    v_add_f32_dpp v13, v13, v13 row_ror:8 row_mask:0xf bank_mask:0xf
    v_add_f32_dpp v14, v14, v14 row_ror:8 row_mask:0xf bank_mask:0xf
    v_add_f32_dpp v15, v15, v15 row_ror:8 row_mask:0xf bank_mask:0xf
    v_add_f32_dpp v12, v12, v12 row_ror:4 row_mask:0xf bank_mask:0xf
    v_add_f32_dpp v13, v13, v13 row_ror:4 row_mask:0xf bank_mask:0xf
    v_add_f32_dpp v14, v14, v14 row_ror:4 row_mask:0xf bank_mask:0xf
    v_add_f32_dpp v15, v15, v15 row_ror:4 row_mask:0xf bank_mask:0xf
    v_add_f32_dpp v12, v12, v12 row_ror:2 row_mask:0xf bank_mask:0xf
    v_add_f32_dpp v13, v13, v13 row_ror:2 row_mask:0xf bank_mask:0xf
    v_add_f32_dpp v14, v14, v14 row_ror:2 row_mask:0xf bank_mask:0xf
    v_add_f32_dpp v15, v15, v15 row_ror:2 row_mask:0xf bank_mask:0xf
    v_add_f32_dpp v17, v12, v12 row_ror:1 row_mask:0xf bank_mask:0x1
    s_nop 1
    v_add_f32_dpp v17, v13, v13 row_ror:1 row_mask:0xf bank_mask:0x2
    s_nop 1
    v_add_f32_dpp v17, v14, v14 row_ror:1 row_mask:0xf bank_mask:0x4
    s_nop 1
    v_add_f32_dpp v17, v15, v15 row_ror:1 row_mask:0xf bank_mask:0x8
    v_cvt_pk_bf16_f32 v18, v16, v17
    v_lshlrev_b32 v19, 16, v18
    v_and_b32 v20, s61, v18
    v_mul_f32 v19, s59, v19
    v_mul_f32 v20, s59, v20
    v_cvt_pk_bf16_f32 v18, v19, v20
    v_lshlrev_b32 v19, 16, v18
    v_and_b32 v20, s61, v18
    ds_write_b32 v4, v19 offset:1024
    ds_write_b32 v4, v20 offset:1040
    v_max3_f32 v24, v24, v19, v20
    s_waitcnt vmcnt(36)
    v_dot2_f32_bf16 v12, v224, v8, 0
    v_dot2_f32_bf16 v13, v228, v8, 0
    v_dot2_f32_bf16 v14, v232, v8, 0
    v_dot2_f32_bf16 v15, v236, v8, 0
    v_dot2_f32_bf16 v12, v225, v9, v12
    v_dot2_f32_bf16 v13, v229, v9, v13
    v_dot2_f32_bf16 v14, v233, v9, v14
    v_dot2_f32_bf16 v15, v237, v9, v15
    v_dot2_f32_bf16 v12, v226, v10, v12
    v_dot2_f32_bf16 v13, v230, v10, v13
    v_dot2_f32_bf16 v14, v234, v10, v14
    v_dot2_f32_bf16 v15, v238, v10, v15
    v_dot2_f32_bf16 v12, v227, v11, v12
    v_dot2_f32_bf16 v13, v231, v11, v13
    v_dot2_f32_bf16 v14, v235, v11, v14
    v_dot2_f32_bf16 v15, v239, v11, v15
    v_add_f32_dpp v12, v12, v12 row_ror:8 row_mask:0xf bank_mask:0xf
    v_add_f32_dpp v13, v13, v13 row_ror:8 row_mask:0xf bank_mask:0xf
    v_add_f32_dpp v14, v14, v14 row_ror:8 row_mask:0xf bank_mask:0xf
    v_add_f32_dpp v15, v15, v15 row_ror:8 row_mask:0xf bank_mask:0xf
    v_add_f32_dpp v12, v12, v12 row_ror:4 row_mask:0xf bank_mask:0xf
    v_add_f32_dpp v13, v13, v13 row_ror:4 row_mask:0xf bank_mask:0xf
    v_add_f32_dpp v14, v14, v14 row_ror:4 row_mask:0xf bank_mask:0xf
    v_add_f32_dpp v15, v15, v15 row_ror:4 row_mask:0xf bank_mask:0xf
    v_add_f32_dpp v12, v12, v12 row_ror:2 row_mask:0xf bank_mask:0xf
    v_add_f32_dpp v13, v13, v13 row_ror:2 row_mask:0xf bank_mask:0xf
    v_add_f32_dpp v14, v14, v14 row_ror:2 row_mask:0xf bank_mask:0xf
    v_add_f32_dpp v15, v15, v15 row_ror:2 row_mask:0xf bank_mask:0xf
    v_add_f32_dpp v16, v12, v12 row_ror:1 row_mask:0xf bank_mask:0x1
    s_nop 1
    v_add_f32_dpp v16, v13, v13 row_ror:1 row_mask:0xf bank_mask:0x2
    s_nop 1
    v_add_f32_dpp v16, v14, v14 row_ror:1 row_mask:0xf bank_mask:0x4
    s_nop 1
    v_add_f32_dpp v16, v15, v15 row_ror:1 row_mask:0xf bank_mask:0x8
    s_waitcnt vmcnt(32)
    v_dot2_f32_bf16 v12, v240, v8, 0
    v_dot2_f32_bf16 v13, v244, v8, 0
    v_dot2_f32_bf16 v14, v248, v8, 0
    v_dot2_f32_bf16 v15, v252, v8, 0
    v_dot2_f32_bf16 v12, v241, v9, v12
    v_dot2_f32_bf16 v13, v245, v9, v13
    v_dot2_f32_bf16 v14, v249, v9, v14
    v_dot2_f32_bf16 v15, v253, v9, v15
    v_dot2_f32_bf16 v12, v242, v10, v12
    v_dot2_f32_bf16 v13, v246, v10, v13
    v_dot2_f32_bf16 v14, v250, v10, v14
    v_dot2_f32_bf16 v15, v254, v10, v15
    v_dot2_f32_bf16 v12, v243, v11, v12
    v_dot2_f32_bf16 v13, v247, v11, v13
    v_dot2_f32_bf16 v14, v251, v11, v14
    v_dot2_f32_bf16 v15, v255, v11, v15
    v_add_f32_dpp v12, v12, v12 row_ror:8 row_mask:0xf bank_mask:0xf
    v_add_f32_dpp v13, v13, v13 row_ror:8 row_mask:0xf bank_mask:0xf
    v_add_f32_dpp v14, v14, v14 row_ror:8 row_mask:0xf bank_mask:0xf
    v_add_f32_dpp v15, v15, v15 row_ror:8 row_mask:0xf bank_mask:0xf
    v_add_f32_dpp v12, v12, v12 row_ror:4 row_mask:0xf bank_mask:0xf
    v_add_f32_dpp v13, v13, v13 row_ror:4 row_mask:0xf bank_mask:0xf
    v_add_f32_dpp v14, v14, v14 row_ror:4 row_mask:0xf bank_mask:0xf
    v_add_f32_dpp v15, v15, v15 row_ror:4 row_mask:0xf bank_mask:0xf
    v_add_f32_dpp v12, v12, v12 row_ror:2 row_mask:0xf bank_mask:0xf
    v_add_f32_dpp v13, v13, v13 row_ror:2 row_mask:0xf bank_mask:0xf
    v_add_f32_dpp v14, v14, v14 row_ror:2 row_mask:0xf bank_mask:0xf
    v_add_f32_dpp v15, v15, v15 row_ror:2 row_mask:0xf bank_mask:0xf
    v_add_f32_dpp v17, v12, v12 row_ror:1 row_mask:0xf bank_mask:0x1
    s_nop 1
    v_add_f32_dpp v17, v13, v13 row_ror:1 row_mask:0xf bank_mask:0x2
    s_nop 1
    v_add_f32_dpp v17, v14, v14 row_ror:1 row_mask:0xf bank_mask:0x4
    s_nop 1
    v_add_f32_dpp v17, v15, v15 row_ror:1 row_mask:0xf bank_mask:0x8
    v_cvt_pk_bf16_f32 v18, v16, v17
    v_lshlrev_b32 v19, 16, v18
    v_and_b32 v20, s61, v18
    v_mul_f32 v19, s59, v19
    v_mul_f32 v20, s59, v20
    v_cvt_pk_bf16_f32 v18, v19, v20
    v_lshlrev_b32 v19, 16, v18
    v_and_b32 v20, s61, v18
    ds_write_b32 v4, v19 offset:1536
    ds_write_b32 v4, v20 offset:1552
    v_max3_f32 v24, v24, v19, v20
    v_add_u32 v4, 2048, v4
    s_waitcnt vmcnt(28)
    v_dot2_f32_bf16 v12, v64, v8, 0
    v_dot2_f32_bf16 v13, v68, v8, 0
    v_dot2_f32_bf16 v14, v72, v8, 0
    v_dot2_f32_bf16 v15, v76, v8, 0
    v_dot2_f32_bf16 v12, v65, v9, v12
    v_dot2_f32_bf16 v13, v69, v9, v13
    v_dot2_f32_bf16 v14, v73, v9, v14
    v_dot2_f32_bf16 v15, v77, v9, v15
    v_dot2_f32_bf16 v12, v66, v10, v12
    v_dot2_f32_bf16 v13, v70, v10, v13
    v_dot2_f32_bf16 v14, v74, v10, v14
    v_dot2_f32_bf16 v15, v78, v10, v15
    v_dot2_f32_bf16 v12, v67, v11, v12
    v_dot2_f32_bf16 v13, v71, v11, v13
    v_dot2_f32_bf16 v14, v75, v11, v14
    v_dot2_f32_bf16 v15, v79, v11, v15
    v_add_f32_dpp v12, v12, v12 row_ror:8 row_mask:0xf bank_mask:0xf
    v_add_f32_dpp v13, v13, v13 row_ror:8 row_mask:0xf bank_mask:0xf
    v_add_f32_dpp v14, v14, v14 row_ror:8 row_mask:0xf bank_mask:0xf
    v_add_f32_dpp v15, v15, v15 row_ror:8 row_mask:0xf bank_mask:0xf
    v_add_f32_dpp v12, v12, v12 row_ror:4 row_mask:0xf bank_mask:0xf
    v_add_f32_dpp v13, v13, v13 row_ror:4 row_mask:0xf bank_mask:0xf
    v_add_f32_dpp v14, v14, v14 row_ror:4 row_mask:0xf bank_mask:0xf
    v_add_f32_dpp v15, v15, v15 row_ror:4 row_mask:0xf bank_mask:0xf
    v_add_f32_dpp v12, v12, v12 row_ror:2 row_mask:0xf bank_mask:0xf
    v_add_f32_dpp v13, v13, v13 row_ror:2 row_mask:0xf bank_mask:0xf
    v_add_f32_dpp v14, v14, v14 row_ror:2 row_mask:0xf bank_mask:0xf
    v_add_f32_dpp v15, v15, v15 row_ror:2 row_mask:0xf bank_mask:0xf
    v_add_f32_dpp v16, v12, v12 row_ror:1 row_mask:0xf bank_mask:0x1
    s_nop 1
    v_add_f32_dpp v16, v13, v13 row_ror:1 row_mask:0xf bank_mask:0x2
    s_nop 1
    v_add_f32_dpp v16, v14, v14 row_ror:1 row_mask:0xf bank_mask:0x4
    s_nop 1
    v_add_f32_dpp v16, v15, v15 row_ror:1 row_mask:0xf bank_mask:0x8
    s_waitcnt vmcnt(24)
    v_dot2_f32_bf16 v12, v80, v8, 0
    v_dot2_f32_bf16 v13, v84, v8, 0
    v_dot2_f32_bf16 v14, v88, v8, 0
    v_dot2_f32_bf16 v15, v92, v8, 0
    v_dot2_f32_bf16 v12, v81, v9, v12
    v_dot2_f32_bf16 v13, v85, v9, v13
    v_dot2_f32_bf16 v14, v89, v9, v14
    v_dot2_f32_bf16 v15, v93, v9, v15
    v_dot2_f32_bf16 v12, v82, v10, v12
    v_dot2_f32_bf16 v13, v86, v10, v13
    v_dot2_f32_bf16 v14, v90, v10, v14
    v_dot2_f32_bf16 v15, v94, v10, v15
    v_dot2_f32_bf16 v12, v83, v11, v12
    v_dot2_f32_bf16 v13, v87, v11, v13
    v_dot2_f32_bf16 v14, v91, v11, v14
    v_dot2_f32_bf16 v15, v95, v11, v15
    v_add_f32_dpp v12, v12, v12 row_ror:8 row_mask:0xf bank_mask:0xf
    v_add_f32_dpp v13, v13, v13 row_ror:8 row_mask:0xf bank_mask:0xf
    v_add_f32_dpp v14, v14, v14 row_ror:8 row_mask:0xf bank_mask:0xf
    v_add_f32_dpp v15, v15, v15 row_ror:8 row_mask:0xf bank_mask:0xf
    v_add_f32_dpp v12, v12, v12 row_ror:4 row_mask:0xf bank_mask:0xf
    v_add_f32_dpp v13, v13, v13 row_ror:4 row_mask:0xf bank_mask:0xf
    v_add_f32_dpp v14, v14, v14 row_ror:4 row_mask:0xf bank_mask:0xf
    v_add_f32_dpp v15, v15, v15 row_ror:4 row_mask:0xf bank_mask:0xf
    v_add_f32_dpp v12, v12, v12 row_ror:2 row_mask:0xf bank_mask:0xf
    v_add_f32_dpp v13, v13, v13 row_ror:2 row_mask:0xf bank_mask:0xf
    v_add_f32_dpp v14, v14, v14 row_ror:2 row_mask:0xf bank_mask:0xf
    v_add_f32_dpp v15, v15, v15 row_ror:2 row_mask:0xf bank_mask:0xf
    v_add_f32_dpp v17, v12, v12 row_ror:1 row_mask:0xf bank_mask:0x1
    s_nop 1
    v_add_f32_dpp v17, v13, v13 row_ror:1 row_mask:0xf bank_mask:0x2
    s_nop 1
    v_add_f32_dpp v17, v14, v14 row_ror:1 row_mask:0xf bank_mask:0x4
    s_nop 1
    v_add_f32_dpp v17, v15, v15 row_ror:1 row_mask:0xf bank_mask:0x8
    v_cvt_pk_bf16_f32 v18, v16, v17
    v_lshlrev_b32 v19, 16, v18
    v_and_b32 v20, s61, v18
    v_mul_f32 v19, s59, v19
    v_mul_f32 v20, s59, v20
    v_cvt_pk_bf16_f32 v18, v19, v20
    v_lshlrev_b32 v19, 16, v18
    v_and_b32 v20, s61, v18
    ds_write_b32 v4, v19 offset:0
    ds_write_b32 v4, v20 offset:16
    v_max3_f32 v24, v24, v19, v20
    s_waitcnt vmcnt(20)
    v_dot2_f32_bf16 v12, v96, v8, 0
    v_dot2_f32_bf16 v13, v100, v8, 0
    v_dot2_f32_bf16 v14, v104, v8, 0
    v_dot2_f32_bf16 v15, v108, v8, 0
    v_dot2_f32_bf16 v12, v97, v9, v12
    v_dot2_f32_bf16 v13, v101, v9, v13
    v_dot2_f32_bf16 v14, v105, v9, v14
    v_dot2_f32_bf16 v15, v109, v9, v15
    v_dot2_f32_bf16 v12, v98, v10, v12
    v_dot2_f32_bf16 v13, v102, v10, v13
    v_dot2_f32_bf16 v14, v106, v10, v14
    v_dot2_f32_bf16 v15, v110, v10, v15
    v_dot2_f32_bf16 v12, v99, v11, v12
    v_dot2_f32_bf16 v13, v103, v11, v13
    v_dot2_f32_bf16 v14, v107, v11, v14
    v_dot2_f32_bf16 v15, v111, v11, v15
    v_add_f32_dpp v12, v12, v12 row_ror:8 row_mask:0xf bank_mask:0xf
    v_add_f32_dpp v13, v13, v13 row_ror:8 row_mask:0xf bank_mask:0xf
    v_add_f32_dpp v14, v14, v14 row_ror:8 row_mask:0xf bank_mask:0xf
    v_add_f32_dpp v15, v15, v15 row_ror:8 row_mask:0xf bank_mask:0xf
    v_add_f32_dpp v12, v12, v12 row_ror:4 row_mask:0xf bank_mask:0xf
    v_add_f32_dpp v13, v13, v13 row_ror:4 row_mask:0xf bank_mask:0xf
    v_add_f32_dpp v14, v14, v14 row_ror:4 row_mask:0xf bank_mask:0xf
    v_add_f32_dpp v15, v15, v15 row_ror:4 row_mask:0xf bank_mask:0xf
    v_add_f32_dpp v12, v12, v12 row_ror:2 row_mask:0xf bank_mask:0xf
    v_add_f32_dpp v13, v13, v13 row_ror:2 row_mask:0xf bank_mask:0xf
    v_add_f32_dpp v14, v14, v14 row_ror:2 row_mask:0xf bank_mask:0xf
    v_add_f32_dpp v15, v15, v15 row_ror:2 row_mask:0xf bank_mask:0xf
    v_add_f32_dpp v16, v12, v12 row_ror:1 row_mask:0xf bank_mask:0x1
    s_nop 1
    v_add_f32_dpp v16, v13, v13 row_ror:1 row_mask:0xf bank_mask:0x2
    s_nop 1
    v_add_f32_dpp v16, v14, v14 row_ror:1 row_mask:0xf bank_mask:0x4
    s_nop 1
    v_add_f32_dpp v16, v15, v15 row_ror:1 row_mask:0xf bank_mask:0x8
    s_waitcnt vmcnt(16)
    v_dot2_f32_bf16 v12, v112, v8, 0
    v_dot2_f32_bf16 v13, v116, v8, 0
    v_dot2_f32_bf16 v14, v120, v8, 0
    v_dot2_f32_bf16 v15, v124, v8, 0
    v_dot2_f32_bf16 v12, v113, v9, v12
    v_dot2_f32_bf16 v13, v117, v9, v13
    v_dot2_f32_bf16 v14, v121, v9, v14
    v_dot2_f32_bf16 v15, v125, v9, v15
    v_dot2_f32_bf16 v12, v114, v10, v12
    v_dot2_f32_bf16 v13, v118, v10, v13
    v_dot2_f32_bf16 v14, v122, v10, v14
    v_dot2_f32_bf16 v15, v126, v10, v15
    v_dot2_f32_bf16 v12, v115, v11, v12
    v_dot2_f32_bf16 v13, v119, v11, v13
    v_dot2_f32_bf16 v14, v123, v11, v14
    v_dot2_f32_bf16 v15, v127, v11, v15
    v_add_f32_dpp v12, v12, v12 row_ror:8 row_mask:0xf bank_mask:0xf
    v_add_f32_dpp v13, v13, v13 row_ror:8 row_mask:0xf bank_mask:0xf
    v_add_f32_dpp v14, v14, v14 row_ror:8 row_mask:0xf bank_mask:0xf
    v_add_f32_dpp v15, v15, v15 row_ror:8 row_mask:0xf bank_mask:0xf
    v_add_f32_dpp v12, v12, v12 row_ror:4 row_mask:0xf bank_mask:0xf
    v_add_f32_dpp v13, v13, v13 row_ror:4 row_mask:0xf bank_mask:0xf
    v_add_f32_dpp v14, v14, v14 row_ror:4 row_mask:0xf bank_mask:0xf
    v_add_f32_dpp v15, v15, v15 row_ror:4 row_mask:0xf bank_mask:0xf
    v_add_f32_dpp v12, v12, v12 row_ror:2 row_mask:0xf bank_mask:0xf
    v_add_f32_dpp v13, v13, v13 row_ror:2 row_mask:0xf bank_mask:0xf
    v_add_f32_dpp v14, v14, v14 row_ror:2 row_mask:0xf bank_mask:0xf
    v_add_f32_dpp v15, v15, v15 row_ror:2 row_mask:0xf bank_mask:0xf
    v_add_f32_dpp v17, v12, v12 row_ror:1 row_mask:0xf bank_mask:0x1
    s_nop 1
    v_add_f32_dpp v17, v13, v13 row_ror:1 row_mask:0xf bank_mask:0x2
    s_nop 1
    v_add_f32_dpp v17, v14, v14 row_ror:1 row_mask:0xf bank_mask:0x4
    s_nop 1
    v_add_f32_dpp v17, v15, v15 row_ror:1 row_mask:0xf bank_mask:0x8
    v_cvt_pk_bf16_f32 v18, v16, v17
    v_lshlrev_b32 v19, 16, v18
    v_and_b32 v20, s61, v18
    v_mul_f32 v19, s59, v19
    v_mul_f32 v20, s59, v20
    v_cvt_pk_bf16_f32 v18, v19, v20
    v_lshlrev_b32 v19, 16, v18
    v_and_b32 v20, s61, v18
    ds_write_b32 v4, v19 offset:512
    ds_write_b32 v4, v20 offset:528
    v_max3_f32 v24, v24, v19, v20
    s_waitcnt vmcnt(12)
    v_dot2_f32_bf16 v12, v128, v8, 0
    v_dot2_f32_bf16 v13, v132, v8, 0
    v_dot2_f32_bf16 v14, v136, v8, 0
    v_dot2_f32_bf16 v15, v140, v8, 0
    v_dot2_f32_bf16 v12, v129, v9, v12
    v_dot2_f32_bf16 v13, v133, v9, v13
    v_dot2_f32_bf16 v14, v137, v9, v14
    v_dot2_f32_bf16 v15, v141, v9, v15
    v_dot2_f32_bf16 v12, v130, v10, v12
    v_dot2_f32_bf16 v13, v134, v10, v13
    v_dot2_f32_bf16 v14, v138, v10, v14
    v_dot2_f32_bf16 v15, v142, v10, v15
    v_dot2_f32_bf16 v12, v131, v11, v12
    v_dot2_f32_bf16 v13, v135, v11, v13
    v_dot2_f32_bf16 v14, v139, v11, v14
    v_dot2_f32_bf16 v15, v143, v11, v15
    v_add_f32_dpp v12, v12, v12 row_ror:8 row_mask:0xf bank_mask:0xf
    v_add_f32_dpp v13, v13, v13 row_ror:8 row_mask:0xf bank_mask:0xf
    v_add_f32_dpp v14, v14, v14 row_ror:8 row_mask:0xf bank_mask:0xf
    v_add_f32_dpp v15, v15, v15 row_ror:8 row_mask:0xf bank_mask:0xf
    v_add_f32_dpp v12, v12, v12 row_ror:4 row_mask:0xf bank_mask:0xf
    v_add_f32_dpp v13, v13, v13 row_ror:4 row_mask:0xf bank_mask:0xf
    v_add_f32_dpp v14, v14, v14 row_ror:4 row_mask:0xf bank_mask:0xf
    v_add_f32_dpp v15, v15, v15 row_ror:4 row_mask:0xf bank_mask:0xf
    v_add_f32_dpp v12, v12, v12 row_ror:2 row_mask:0xf bank_mask:0xf
    v_add_f32_dpp v13, v13, v13 row_ror:2 row_mask:0xf bank_mask:0xf
    v_add_f32_dpp v14, v14, v14 row_ror:2 row_mask:0xf bank_mask:0xf
    v_add_f32_dpp v15, v15, v15 row_ror:2 row_mask:0xf bank_mask:0xf
    v_add_f32_dpp v16, v12, v12 row_ror:1 row_mask:0xf bank_mask:0x1
    s_nop 1
    v_add_f32_dpp v16, v13, v13 row_ror:1 row_mask:0xf bank_mask:0x2
    s_nop 1
    v_add_f32_dpp v16, v14, v14 row_ror:1 row_mask:0xf bank_mask:0x4
    s_nop 1
    v_add_f32_dpp v16, v15, v15 row_ror:1 row_mask:0xf bank_mask:0x8
    s_waitcnt vmcnt(8)
    v_dot2_f32_bf16 v12, v144, v8, 0
    v_dot2_f32_bf16 v13, v148, v8, 0
    v_dot2_f32_bf16 v14, v152, v8, 0
    v_dot2_f32_bf16 v15, v156, v8, 0
    v_dot2_f32_bf16 v12, v145, v9, v12
    v_dot2_f32_bf16 v13, v149, v9, v13
    v_dot2_f32_bf16 v14, v153, v9, v14
    v_dot2_f32_bf16 v15, v157, v9, v15
    v_dot2_f32_bf16 v12, v146, v10, v12
    v_dot2_f32_bf16 v13, v150, v10, v13
    v_dot2_f32_bf16 v14, v154, v10, v14
    v_dot2_f32_bf16 v15, v158, v10, v15
    v_dot2_f32_bf16 v12, v147, v11, v12
    v_dot2_f32_bf16 v13, v151, v11, v13
    v_dot2_f32_bf16 v14, v155, v11, v14
    v_dot2_f32_bf16 v15, v159, v11, v15
    v_add_f32_dpp v12, v12, v12 row_ror:8 row_mask:0xf bank_mask:0xf
    v_add_f32_dpp v13, v13, v13 row_ror:8 row_mask:0xf bank_mask:0xf
    v_add_f32_dpp v14, v14, v14 row_ror:8 row_mask:0xf bank_mask:0xf
    v_add_f32_dpp v15, v15, v15 row_ror:8 row_mask:0xf bank_mask:0xf
    v_add_f32_dpp v12, v12, v12 row_ror:4 row_mask:0xf bank_mask:0xf
    v_add_f32_dpp v13, v13, v13 row_ror:4 row_mask:0xf bank_mask:0xf
    v_add_f32_dpp v14, v14, v14 row_ror:4 row_mask:0xf bank_mask:0xf
    v_add_f32_dpp v15, v15, v15 row_ror:4 row_mask:0xf bank_mask:0xf
    v_add_f32_dpp v12, v12, v12 row_ror:2 row_mask:0xf bank_mask:0xf
    v_add_f32_dpp v13, v13, v13 row_ror:2 row_mask:0xf bank_mask:0xf
    v_add_f32_dpp v14, v14, v14 row_ror:2 row_mask:0xf bank_mask:0xf
    v_add_f32_dpp v15, v15, v15 row_ror:2 row_mask:0xf bank_mask:0xf
    v_add_f32_dpp v17, v12, v12 row_ror:1 row_mask:0xf bank_mask:0x1
    s_nop 1
    v_add_f32_dpp v17, v13, v13 row_ror:1 row_mask:0xf bank_mask:0x2
    s_nop 1
    v_add_f32_dpp v17, v14, v14 row_ror:1 row_mask:0xf bank_mask:0x4
    s_nop 1
    v_add_f32_dpp v17, v15, v15 row_ror:1 row_mask:0xf bank_mask:0x8
    v_cvt_pk_bf16_f32 v18, v16, v17
    v_lshlrev_b32 v19, 16, v18
    v_and_b32 v20, s61, v18
    v_mul_f32 v19, s59, v19
    v_mul_f32 v20, s59, v20
    v_cvt_pk_bf16_f32 v18, v19, v20
    v_lshlrev_b32 v19, 16, v18
    v_and_b32 v20, s61, v18
    ds_write_b32 v4, v19 offset:1024
    ds_write_b32 v4, v20 offset:1040
    v_max3_f32 v24, v24, v19, v20
    s_waitcnt vmcnt(4)
    buffer_load_dwordx4 v[128:131], v2, s[28:31], s56 offen offset:0 nt
    buffer_load_dwordx4 v[132:135], v2, s[28:31], s56 offen offset:1024 nt
    buffer_load_dwordx4 v[136:139], v2, s[28:31], s56 offen offset:2048 nt
    buffer_load_dwordx4 v[140:143], v2, s[28:31], s56 offen offset:3072 nt
    s_add_u32 s56, s56, 4096
    v_dot2_f32_bf16 v12, v160, v8, 0
    v_dot2_f32_bf16 v13, v164, v8, 0
    v_dot2_f32_bf16 v14, v168, v8, 0
    v_dot2_f32_bf16 v15, v172, v8, 0
    v_dot2_f32_bf16 v12, v161, v9, v12
    v_dot2_f32_bf16 v13, v165, v9, v13
    v_dot2_f32_bf16 v14, v169, v9, v14
    v_dot2_f32_bf16 v15, v173, v9, v15
    v_dot2_f32_bf16 v12, v162, v10, v12
    v_dot2_f32_bf16 v13, v166, v10, v13
    v_dot2_f32_bf16 v14, v170, v10, v14
    v_dot2_f32_bf16 v15, v174, v10, v15
    v_dot2_f32_bf16 v12, v163, v11, v12
    v_dot2_f32_bf16 v13, v167, v11, v13
    v_dot2_f32_bf16 v14, v171, v11, v14
    v_dot2_f32_bf16 v15, v175, v11, v15
    v_add_f32_dpp v12, v12, v12 row_ror:8 row_mask:0xf bank_mask:0xf
    v_add_f32_dpp v13, v13, v13 row_ror:8 row_mask:0xf bank_mask:0xf
    v_add_f32_dpp v14, v14, v14 row_ror:8 row_mask:0xf bank_mask:0xf
    v_add_f32_dpp v15, v15, v15 row_ror:8 row_mask:0xf bank_mask:0xf
    v_add_f32_dpp v12, v12, v12 row_ror:4 row_mask:0xf bank_mask:0xf
    v_add_f32_dpp v13, v13, v13 row_ror:4 row_mask:0xf bank_mask:0xf
    v_add_f32_dpp v14, v14, v14 row_ror:4 row_mask:0xf bank_mask:0xf
    v_add_f32_dpp v15, v15, v15 row_ror:4 row_mask:0xf bank_mask:0xf
    v_add_f32_dpp v12, v12, v12 row_ror:2 row_mask:0xf bank_mask:0xf
    v_add_f32_dpp v13, v13, v13 row_ror:2 row_mask:0xf bank_mask:0xf
    v_add_f32_dpp v14, v14, v14 row_ror:2 row_mask:0xf bank_mask:0xf
    v_add_f32_dpp v15, v15, v15 row_ror:2 row_mask:0xf bank_mask:0xf
    v_add_f32_dpp v16, v12, v12 row_ror:1 row_mask:0xf bank_mask:0x1
    s_nop 1
    v_add_f32_dpp v16, v13, v13 row_ror:1 row_mask:0xf bank_mask:0x2
    s_nop 1
    v_add_f32_dpp v16, v14, v14 row_ror:1 row_mask:0xf bank_mask:0x4
    s_nop 1
    v_add_f32_dpp v16, v15, v15 row_ror:1 row_mask:0xf bank_mask:0x8
    s_waitcnt vmcnt(4)
    buffer_load_dwordx4 v[144:147], v2, s[28:31], s56 offen offset:0 nt
    buffer_load_dwordx4 v[148:151], v2, s[28:31], s56 offen offset:1024 nt
    buffer_load_dwordx4 v[152:155], v2, s[28:31], s56 offen offset:2048 nt
    buffer_load_dwordx4 v[156:159], v2, s[28:31], s56 offen offset:3072 nt
    s_add_u32 s56, s56, 28672
    v_dot2_f32_bf16 v12, v176, v8, 0
    v_dot2_f32_bf16 v13, v180, v8, 0
    v_dot2_f32_bf16 v14, v184, v8, 0
    v_dot2_f32_bf16 v15, v188, v8, 0
    v_dot2_f32_bf16 v12, v177, v9, v12
    v_dot2_f32_bf16 v13, v181, v9, v13
    v_dot2_f32_bf16 v14, v185, v9, v14
    v_dot2_f32_bf16 v15, v189, v9, v15
    v_dot2_f32_bf16 v12, v178, v10, v12
    v_dot2_f32_bf16 v13, v182, v10, v13
    v_dot2_f32_bf16 v14, v186, v10, v14
    v_dot2_f32_bf16 v15, v190, v10, v15
    v_dot2_f32_bf16 v12, v179, v11, v12
    v_dot2_f32_bf16 v13, v183, v11, v13
    v_dot2_f32_bf16 v14, v187, v11, v14
    v_dot2_f32_bf16 v15, v191, v11, v15
    v_add_f32_dpp v12, v12, v12 row_ror:8 row_mask:0xf bank_mask:0xf
    v_add_f32_dpp v13, v13, v13 row_ror:8 row_mask:0xf bank_mask:0xf
    v_add_f32_dpp v14, v14, v14 row_ror:8 row_mask:0xf bank_mask:0xf
    v_add_f32_dpp v15, v15, v15 row_ror:8 row_mask:0xf bank_mask:0xf
    v_add_f32_dpp v12, v12, v12 row_ror:4 row_mask:0xf bank_mask:0xf
    v_add_f32_dpp v13, v13, v13 row_ror:4 row_mask:0xf bank_mask:0xf
    v_add_f32_dpp v14, v14, v14 row_ror:4 row_mask:0xf bank_mask:0xf
    v_add_f32_dpp v15, v15, v15 row_ror:4 row_mask:0xf bank_mask:0xf
    v_add_f32_dpp v12, v12, v12 row_ror:2 row_mask:0xf bank_mask:0xf
    v_add_f32_dpp v13, v13, v13 row_ror:2 row_mask:0xf bank_mask:0xf
    v_add_f32_dpp v14, v14, v14 row_ror:2 row_mask:0xf bank_mask:0xf
    v_add_f32_dpp v15, v15, v15 row_ror:2 row_mask:0xf bank_mask:0xf
    v_add_f32_dpp v17, v12, v12 row_ror:1 row_mask:0xf bank_mask:0x1
    s_nop 1
    v_add_f32_dpp v17, v13, v13 row_ror:1 row_mask:0xf bank_mask:0x2
    s_nop 1
    v_add_f32_dpp v17, v14, v14 row_ror:1 row_mask:0xf bank_mask:0x4
    s_nop 1
    v_add_f32_dpp v17, v15, v15 row_ror:1 row_mask:0xf bank_mask:0x8
    v_cvt_pk_bf16_f32 v18, v16, v17
    v_lshlrev_b32 v19, 16, v18
    v_and_b32 v20, s61, v18
    v_mul_f32 v19, s59, v19
    v_mul_f32 v20, s59, v20
    v_cvt_pk_bf16_f32 v18, v19, v20
    v_lshlrev_b32 v19, 16, v18
    v_and_b32 v20, s61, v18
    ds_write_b32 v4, v19 offset:1536
    ds_write_b32 v4, v20 offset:1552
    v_max3_f32 v24, v24, v19, v20
    v_add_u32 v4, 2048, v4
    s_mov_b32 s58, 5
L_kloop:
    s_waitcnt vmcnt(4)
    buffer_load_dwordx4 v[160:163], v2, s[28:31], s56 offen offset:0 nt
    buffer_load_dwordx4 v[164:167], v2, s[28:31], s56 offen offset:1024 nt
    buffer_load_dwordx4 v[168:171], v2, s[28:31], s56 offen offset:2048 nt
    buffer_load_dwordx4 v[172:175], v2, s[28:31], s56 offen offset:3072 nt
    s_add_u32 s56, s56, 4096
    v_dot2_f32_bf16 v12, v128, v8, 0
    v_dot2_f32_bf16 v13, v132, v8, 0
    v_dot2_f32_bf16 v14, v136, v8, 0
    v_dot2_f32_bf16 v15, v140, v8, 0
    v_dot2_f32_bf16 v12, v129, v9, v12
    v_dot2_f32_bf16 v13, v133, v9, v13
    v_dot2_f32_bf16 v14, v137, v9, v14
    v_dot2_f32_bf16 v15, v141, v9, v15
    v_dot2_f32_bf16 v12, v130, v10, v12
    v_dot2_f32_bf16 v13, v134, v10, v13
    v_dot2_f32_bf16 v14, v138, v10, v14
    v_dot2_f32_bf16 v15, v142, v10, v15
    v_dot2_f32_bf16 v12, v131, v11, v12
    v_dot2_f32_bf16 v13, v135, v11, v13
    v_dot2_f32_bf16 v14, v139, v11, v14
    v_dot2_f32_bf16 v15, v143, v11, v15
    v_add_f32_dpp v12, v12, v12 row_ror:8 row_mask:0xf bank_mask:0xf
    v_add_f32_dpp v13, v13, v13 row_ror:8 row_mask:0xf bank_mask:0xf
    v_add_f32_dpp v14, v14, v14 row_ror:8 row_mask:0xf bank_mask:0xf
    v_add_f32_dpp v15, v15, v15 row_ror:8 row_mask:0xf bank_mask:0xf
    v_add_f32_dpp v12, v12, v12 row_ror:4 row_mask:0xf bank_mask:0xf
    v_add_f32_dpp v13, v13, v13 row_ror:4 row_mask:0xf bank_mask:0xf
    v_add_f32_dpp v14, v14, v14 row_ror:4 row_mask:0xf bank_mask:0xf
    v_add_f32_dpp v15, v15, v15 row_ror:4 row_mask:0xf bank_mask:0xf
    v_add_f32_dpp v12, v12, v12 row_ror:2 row_mask:0xf bank_mask:0xf
    v_add_f32_dpp v13, v13, v13 row_ror:2 row_mask:0xf bank_mask:0xf
    v_add_f32_dpp v14, v14, v14 row_ror:2 row_mask:0xf bank_mask:0xf
    v_add_f32_dpp v15, v15, v15 row_ror:2 row_mask:0xf bank_mask:0xf
    v_add_f32_dpp v16, v12, v12 row_ror:1 row_mask:0xf bank_mask:0x1
    s_nop 1
    v_add_f32_dpp v16, v13, v13 row_ror:1 row_mask:0xf bank_mask:0x2
    s_nop 1
    v_add_f32_dpp v16, v14, v14 row_ror:1 row_mask:0xf bank_mask:0x4
    s_nop 1
    v_add_f32_dpp v16, v15, v15 row_ror:1 row_mask:0xf bank_mask:0x8
    s_waitcnt vmcnt(4)
    buffer_load_dwordx4 v[176:179], v2, s[28:31], s56 offen offset:0 nt
    buffer_load_dwordx4 v[180:183], v2, s[28:31], s56 offen offset:1024 nt
    buffer_load_dwordx4 v[184:187], v2, s[28:31], s56 offen offset:2048 nt
    buffer_load_dwordx4 v[188:191], v2, s[28:31], s56 offen offset:3072 nt
    s_add_u32 s56, s56, 28672
    v_dot2_f32_bf16 v12, v144, v8, 0
    v_dot2_f32_bf16 v13, v148, v8, 0
    v_dot2_f32_bf16 v14, v152, v8, 0
    v_dot2_f32_bf16 v15, v156, v8, 0
    v_dot2_f32_bf16 v12, v145, v9, v12
    v_dot2_f32_bf16 v13, v149, v9, v13
    v_dot2_f32_bf16 v14, v153, v9, v14
    v_dot2_f32_bf16 v15, v157, v9, v15
    v_dot2_f32_bf16 v12, v146, v10, v12
    v_dot2_f32_bf16 v13, v150, v10, v13
    v_dot2_f32_bf16 v14, v154, v10, v14
    v_dot2_f32_bf16 v15, v158, v10, v15
    v_dot2_f32_bf16 v12, v147, v11, v12
    v_dot2_f32_bf16 v13, v151, v11, v13
    v_dot2_f32_bf16 v14, v155, v11, v14
    v_dot2_f32_bf16 v15, v159, v11, v15
    v_add_f32_dpp v12, v12, v12 row_ror:8 row_mask:0xf bank_mask:0xf
    v_add_f32_dpp v13, v13, v13 row_ror:8 row_mask:0xf bank_mask:0xf
    v_add_f32_dpp v14, v14, v14 row_ror:8 row_mask:0xf bank_mask:0xf
    v_add_f32_dpp v15, v15, v15 row_ror:8 row_mask:0xf bank_mask:0xf
    v_add_f32_dpp v12, v12, v12 row_ror:4 row_mask:0xf bank_mask:0xf
    v_add_f32_dpp v13, v13, v13 row_ror:4 row_mask:0xf bank_mask:0xf
    v_add_f32_dpp v14, v14, v14 row_ror:4 row_mask:0xf bank_mask:0xf
    v_add_f32_dpp v15, v15, v15 row_ror:4 row_mask:0xf bank_mask:0xf
    v_add_f32_dpp v12, v12, v12 row_ror:2 row_mask:0xf bank_mask:0xf
    v_add_f32_dpp v13, v13, v13 row_ror:2 row_mask:0xf bank_mask:0xf
    v_add_f32_dpp v14, v14, v14 row_ror:2 row_mask:0xf bank_mask:0xf
    v_add_f32_dpp v15, v15, v15 row_ror:2 row_mask:0xf bank_mask:0xf
    v_add_f32_dpp v17, v12, v12 row_ror:1 row_mask:0xf bank_mask:0x1
    s_nop 1
    v_add_f32_dpp v17, v13, v13 row_ror:1 row_mask:0xf bank_mask:0x2
    s_nop 1
    v_add_f32_dpp v17, v14, v14 row_ror:1 row_mask:0xf bank_mask:0x4
    s_nop 1
    v_add_f32_dpp v17, v15, v15 row_ror:1 row_mask:0xf bank_mask:0x8
    v_cvt_pk_bf16_f32 v18, v16, v17
    v_lshlrev_b32 v19, 16, v18
    v_and_b32 v20, s61, v18
    v_mul_f32 v19, s59, v19
    v_mul_f32 v20, s59, v20
    v_cvt_pk_bf16_f32 v18, v19, v20
    v_lshlrev_b32 v19, 16, v18
    v_and_b32 v20, s61, v18
    ds_write_b32 v4, v19 offset:0
    ds_write_b32 v4, v20 offset:16
    v_max3_f32 v24, v24, v19, v20
    s_waitcnt vmcnt(4)
    buffer_load_dwordx4 v[192:195], v2, s[28:31], s56 offen offset:0 nt
    buffer_load_dwordx4 v[196:199], v2, s[28:31], s56 offen offset:1024 nt
    buffer_load_dwordx4 v[200:203], v2, s[28:31], s56 offen offset:2048 nt
    buffer_load_dwordx4 v[204:207], v2, s[28:31], s56 offen offset:3072 nt
    s_add_u32 s56, s56, 4096
    v_dot2_f32_bf16 v12, v160, v8, 0
    v_dot2_f32_bf16 v13, v164, v8, 0
    v_dot2_f32_bf16 v14, v168, v8, 0
    v_dot2_f32_bf16 v15, v172, v8, 0
    v_dot2_f32_bf16 v12, v161, v9, v12
    v_dot2_f32_bf16 v13, v165, v9, v13
    v_dot2_f32_bf16 v14, v169, v9, v14
    v_dot2_f32_bf16 v15, v173, v9, v15
    v_dot2_f32_bf16 v12, v162, v10, v12
    v_dot2_f32_bf16 v13, v166, v10, v13
    v_dot2_f32_bf16 v14, v170, v10, v14
    v_dot2_f32_bf16 v15, v174, v10, v15
    v_dot2_f32_bf16 v12, v163, v11, v12
    v_dot2_f32_bf16 v13, v167, v11, v13
    v_dot2_f32_bf16 v14, v171, v11, v14
    v_dot2_f32_bf16 v15, v175, v11, v15
    v_add_f32_dpp v12, v12, v12 row_ror:8 row_mask:0xf bank_mask:0xf
    v_add_f32_dpp v13, v13, v13 row_ror:8 row_mask:0xf bank_mask:0xf
    v_add_f32_dpp v14, v14, v14 row_ror:8 row_mask:0xf bank_mask:0xf
    v_add_f32_dpp v15, v15, v15 row_ror:8 row_mask:0xf bank_mask:0xf
    v_add_f32_dpp v12, v12, v12 row_ror:4 row_mask:0xf bank_mask:0xf
    v_add_f32_dpp v13, v13, v13 row_ror:4 row_mask:0xf bank_mask:0xf
    v_add_f32_dpp v14, v14, v14 row_ror:4 row_mask:0xf bank_mask:0xf
    v_add_f32_dpp v15, v15, v15 row_ror:4 row_mask:0xf bank_mask:0xf
    v_add_f32_dpp v12, v12, v12 row_ror:2 row_mask:0xf bank_mask:0xf
    v_add_f32_dpp v13, v13, v13 row_ror:2 row_mask:0xf bank_mask:0xf
    v_add_f32_dpp v14, v14, v14 row_ror:2 row_mask:0xf bank_mask:0xf
    v_add_f32_dpp v15, v15, v15 row_ror:2 row_mask:0xf bank_mask:0xf
    v_add_f32_dpp v16, v12, v12 row_ror:1 row_mask:0xf bank_mask:0x1
    s_nop 1
    v_add_f32_dpp v16, v13, v13 row_ror:1 row_mask:0xf bank_mask:0x2
    s_nop 1
    v_add_f32_dpp v16, v14, v14 row_ror:1 row_mask:0xf bank_mask:0x4
    s_nop 1
    v_add_f32_dpp v16, v15, v15 row_ror:1 row_mask:0xf bank_mask:0x8
    s_waitcnt vmcnt(4)
    buffer_load_dwordx4 v[208:211], v2, s[28:31], s56 offen offset:0 nt
    buffer_load_dwordx4 v[212:215], v2, s[28:31], s56 offen offset:1024 nt
    buffer_load_dwordx4 v[216:219], v2, s[28:31], s56 offen offset:2048 nt
    buffer_load_dwordx4 v[220:223], v2, s[28:31], s56 offen offset:3072 nt
    s_add_u32 s56, s56, 28672
    v_dot2_f32_bf16 v12, v176, v8, 0
    v_dot2_f32_bf16 v13, v180, v8, 0
    v_dot2_f32_bf16 v14, v184, v8, 0
    v_dot2_f32_bf16 v15, v188, v8, 0
    v_dot2_f32_bf16 v12, v177, v9, v12
    v_dot2_f32_bf16 v13, v181, v9, v13
    v_dot2_f32_bf16 v14, v185, v9, v14
    v_dot2_f32_bf16 v15, v189, v9, v15
    v_dot2_f32_bf16 v12, v178, v10, v12
    v_dot2_f32_bf16 v13, v182, v10, v13
    v_dot2_f32_bf16 v14, v186, v10, v14
    v_dot2_f32_bf16 v15, v190, v10, v15
    v_dot2_f32_bf16 v12, v179, v11, v12
    v_dot2_f32_bf16 v13, v183, v11, v13
    v_dot2_f32_bf16 v14, v187, v11, v14
    v_dot2_f32_bf16 v15, v191, v11, v15
    v_add_f32_dpp v12, v12, v12 row_ror:8 row_mask:0xf bank_mask:0xf
    v_add_f32_dpp v13, v13, v13 row_ror:8 row_mask:0xf bank_mask:0xf
    v_add_f32_dpp v14, v14, v14 row_ror:8 row_mask:0xf bank_mask:0xf
    v_add_f32_dpp v15, v15, v15 row_ror:8 row_mask:0xf bank_mask:0xf
    v_add_f32_dpp v12, v12, v12 row_ror:4 row_mask:0xf bank_mask:0xf
    v_add_f32_dpp v13, v13, v13 row_ror:4 row_mask:0xf bank_mask:0xf
    v_add_f32_dpp v14, v14, v14 row_ror:4 row_mask:0xf bank_mask:0xf
    v_add_f32_dpp v15, v15, v15 row_ror:4 row_mask:0xf bank_mask:0xf
    v_add_f32_dpp v12, v12, v12 row_ror:2 row_mask:0xf bank_mask:0xf
    v_add_f32_dpp v13, v13, v13 row_ror:2 row_mask:0xf bank_mask:0xf
    v_add_f32_dpp v14, v14, v14 row_ror:2 row_mask:0xf bank_mask:0xf
    v_add_f32_dpp v15, v15, v15 row_ror:2 row_mask:0xf bank_mask:0xf
    v_add_f32_dpp v17, v12, v12 row_ror:1 row_mask:0xf bank_mask:0x1
    s_nop 1
    v_add_f32_dpp v17, v13, v13 row_ror:1 row_mask:0xf bank_mask:0x2
    s_nop 1
    v_add_f32_dpp v17, v14, v14 row_ror:1 row_mask:0xf bank_mask:0x4
    s_nop 1
    v_add_f32_dpp v17, v15, v15 row_ror:1 row_mask:0xf bank_mask:0x8
    v_cvt_pk_bf16_f32 v18, v16, v17
    v_lshlrev_b32 v19, 16, v18
    v_and_b32 v20, s61, v18
    v_mul_f32 v19, s59, v19
    v_mul_f32 v20, s59, v20
    v_cvt_pk_bf16_f32 v18, v19, v20
    v_lshlrev_b32 v19, 16, v18
    v_and_b32 v20, s61, v18
    ds_write_b32 v4, v19 offset:512
    ds_write_b32 v4, v20 offset:528
    v_max3_f32 v24, v24, v19, v20
    s_waitcnt vmcnt(4)
    buffer_load_dwordx4 v[224:227], v2, s[28:31], s56 offen offset:0 nt
    buffer_load_dwordx4 v[228:231], v2, s[28:31], s56 offen offset:1024 nt
    buffer_load_dwordx4 v[232:235], v2, s[28:31], s56 offen offset:2048 nt
    buffer_load_dwordx4 v[236:239], v2, s[28:31], s56 offen offset:3072 nt
    s_add_u32 s56, s56, 4096
    v_dot2_f32_bf16 v12, v192, v8, 0
    v_dot2_f32_bf16 v13, v196, v8, 0
    v_dot2_f32_bf16 v14, v200, v8, 0
    v_dot2_f32_bf16 v15, v204, v8, 0
    v_dot2_f32_bf16 v12, v193, v9, v12
    v_dot2_f32_bf16 v13, v197, v9, v13
    v_dot2_f32_bf16 v14, v201, v9, v14
    v_dot2_f32_bf16 v15, v205, v9, v15
    v_dot2_f32_bf16 v12, v194, v10, v12
    v_dot2_f32_bf16 v13, v198, v10, v13
    v_dot2_f32_bf16 v14, v202, v10, v14
    v_dot2_f32_bf16 v15, v206, v10, v15
    v_dot2_f32_bf16 v12, v195, v11, v12
    v_dot2_f32_bf16 v13, v199, v11, v13
    v_dot2_f32_bf16 v14, v203, v11, v14
    v_dot2_f32_bf16 v15, v207, v11, v15
    v_add_f32_dpp v12, v12, v12 row_ror:8 row_mask:0xf bank_mask:0xf
    v_add_f32_dpp v13, v13, v13 row_ror:8 row_mask:0xf bank_mask:0xf
    v_add_f32_dpp v14, v14, v14 row_ror:8 row_mask:0xf bank_mask:0xf
    v_add_f32_dpp v15, v15, v15 row_ror:8 row_mask:0xf bank_mask:0xf
    v_add_f32_dpp v12, v12, v12 row_ror:4 row_mask:0xf bank_mask:0xf
    v_add_f32_dpp v13, v13, v13 row_ror:4 row_mask:0xf bank_mask:0xf
    v_add_f32_dpp v14, v14, v14 row_ror:4 row_mask:0xf bank_mask:0xf
    v_add_f32_dpp v15, v15, v15 row_ror:4 row_mask:0xf bank_mask:0xf
    v_add_f32_dpp v12, v12, v12 row_ror:2 row_mask:0xf bank_mask:0xf
    v_add_f32_dpp v13, v13, v13 row_ror:2 row_mask:0xf bank_mask:0xf
    v_add_f32_dpp v14, v14, v14 row_ror:2 row_mask:0xf bank_mask:0xf
    v_add_f32_dpp v15, v15, v15 row_ror:2 row_mask:0xf bank_mask:0xf
    v_add_f32_dpp v16, v12, v12 row_ror:1 row_mask:0xf bank_mask:0x1
    s_nop 1
    v_add_f32_dpp v16, v13, v13 row_ror:1 row_mask:0xf bank_mask:0x2
    s_nop 1
    v_add_f32_dpp v16, v14, v14 row_ror:1 row_mask:0xf bank_mask:0x4
    s_nop 1
    v_add_f32_dpp v16, v15, v15 row_ror:1 row_mask:0xf bank_mask:0x8
    s_waitcnt vmcnt(4)
    buffer_load_dwordx4 v[240:243], v2, s[28:31], s56 offen offset:0 nt
    buffer_load_dwordx4 v[244:247], v2, s[28:31], s56 offen offset:1024 nt
    buffer_load_dwordx4 v[248:251], v2, s[28:31], s56 offen offset:2048 nt
    buffer_load_dwordx4 v[252:255], v2, s[28:31], s56 offen offset:3072 nt
    s_add_u32 s56, s56, 28672
    v_dot2_f32_bf16 v12, v208, v8, 0
    v_dot2_f32_bf16 v13, v212, v8, 0
    v_dot2_f32_bf16 v14, v216, v8, 0
    v_dot2_f32_bf16 v15, v220, v8, 0
    v_dot2_f32_bf16 v12, v209, v9, v12
    v_dot2_f32_bf16 v13, v213, v9, v13
    v_dot2_f32_bf16 v14, v217, v9, v14
    v_dot2_f32_bf16 v15, v221, v9, v15
    v_dot2_f32_bf16 v12, v210, v10, v12
    v_dot2_f32_bf16 v13, v214, v10, v13
    v_dot2_f32_bf16 v14, v218, v10, v14
    v_dot2_f32_bf16 v15, v222, v10, v15
    v_dot2_f32_bf16 v12, v211, v11, v12
    v_dot2_f32_bf16 v13, v215, v11, v13
    v_dot2_f32_bf16 v14, v219, v11, v14
    v_dot2_f32_bf16 v15, v223, v11, v15
    v_add_f32_dpp v12, v12, v12 row_ror:8 row_mask:0xf bank_mask:0xf
    v_add_f32_dpp v13, v13, v13 row_ror:8 row_mask:0xf bank_mask:0xf
    v_add_f32_dpp v14, v14, v14 row_ror:8 row_mask:0xf bank_mask:0xf
    v_add_f32_dpp v15, v15, v15 row_ror:8 row_mask:0xf bank_mask:0xf
    v_add_f32_dpp v12, v12, v12 row_ror:4 row_mask:0xf bank_mask:0xf
    v_add_f32_dpp v13, v13, v13 row_ror:4 row_mask:0xf bank_mask:0xf
    v_add_f32_dpp v14, v14, v14 row_ror:4 row_mask:0xf bank_mask:0xf
    v_add_f32_dpp v15, v15, v15 row_ror:4 row_mask:0xf bank_mask:0xf
    v_add_f32_dpp v12, v12, v12 row_ror:2 row_mask:0xf bank_mask:0xf
    v_add_f32_dpp v13, v13, v13 row_ror:2 row_mask:0xf bank_mask:0xf
    v_add_f32_dpp v14, v14, v14 row_ror:2 row_mask:0xf bank_mask:0xf
    v_add_f32_dpp v15, v15, v15 row_ror:2 row_mask:0xf bank_mask:0xf
    v_add_f32_dpp v17, v12, v12 row_ror:1 row_mask:0xf bank_mask:0x1
    s_nop 1
    v_add_f32_dpp v17, v13, v13 row_ror:1 row_mask:0xf bank_mask:0x2
    s_nop 1
    v_add_f32_dpp v17, v14, v14 row_ror:1 row_mask:0xf bank_mask:0x4
    s_nop 1
    v_add_f32_dpp v17, v15, v15 row_ror:1 row_mask:0xf bank_mask:0x8
    v_cvt_pk_bf16_f32 v18, v16, v17
    v_lshlrev_b32 v19, 16, v18
    v_and_b32 v20, s61, v18
    v_mul_f32 v19, s59, v19
    v_mul_f32 v20, s59, v20
    v_cvt_pk_bf16_f32 v18, v19, v20
    v_lshlrev_b32 v19, 16, v18
    v_and_b32 v20, s61, v18
    ds_write_b32 v4, v19 offset:1024
    ds_write_b32 v4, v20 offset:1040
    v_max3_f32 v24, v24, v19, v20
    s_waitcnt vmcnt(4)
    buffer_load_dwordx4 v[128:131], v2, s[28:31], s56 offen offset:0 nt
    buffer_load_dwordx4 v[132:135], v2, s[28:31], s56 offen offset:1024 nt
    buffer_load_dwordx4 v[136:139], v2, s[28:31], s56 offen offset:2048 nt
    buffer_load_dwordx4 v[140:143], v2, s[28:31], s56 offen offset:3072 nt
    s_add_u32 s56, s56, 4096
    v_dot2_f32_bf16 v12, v224, v8, 0
    v_dot2_f32_bf16 v13, v228, v8, 0
    v_dot2_f32_bf16 v14, v232, v8, 0
    v_dot2_f32_bf16 v15, v236, v8, 0
    v_dot2_f32_bf16 v12, v225, v9, v12
    v_dot2_f32_bf16 v13, v229, v9, v13
    v_dot2_f32_bf16 v14, v233, v9, v14
    v_dot2_f32_bf16 v15, v237, v9, v15
    v_dot2_f32_bf16 v12, v226, v10, v12
    v_dot2_f32_bf16 v13, v230, v10, v13
    v_dot2_f32_bf16 v14, v234, v10, v14
    v_dot2_f32_bf16 v15, v238, v10, v15
    v_dot2_f32_bf16 v12, v227, v11, v12
    v_dot2_f32_bf16 v13, v231, v11, v13
    v_dot2_f32_bf16 v14, v235, v11, v14
    v_dot2_f32_bf16 v15, v239, v11, v15
    v_add_f32_dpp v12, v12, v12 row_ror:8 row_mask:0xf bank_mask:0xf
    v_add_f32_dpp v13, v13, v13 row_ror:8 row_mask:0xf bank_mask:0xf
    v_add_f32_dpp v14, v14, v14 row_ror:8 row_mask:0xf bank_mask:0xf
    v_add_f32_dpp v15, v15, v15 row_ror:8 row_mask:0xf bank_mask:0xf
    v_add_f32_dpp v12, v12, v12 row_ror:4 row_mask:0xf bank_mask:0xf
    v_add_f32_dpp v13, v13, v13 row_ror:4 row_mask:0xf bank_mask:0xf
    v_add_f32_dpp v14, v14, v14 row_ror:4 row_mask:0xf bank_mask:0xf
    v_add_f32_dpp v15, v15, v15 row_ror:4 row_mask:0xf bank_mask:0xf
    v_add_f32_dpp v12, v12, v12 row_ror:2 row_mask:0xf bank_mask:0xf
    v_add_f32_dpp v13, v13, v13 row_ror:2 row_mask:0xf bank_mask:0xf
    v_add_f32_dpp v14, v14, v14 row_ror:2 row_mask:0xf bank_mask:0xf
    v_add_f32_dpp v15, v15, v15 row_ror:2 row_mask:0xf bank_mask:0xf
    v_add_f32_dpp v16, v12, v12 row_ror:1 row_mask:0xf bank_mask:0x1
    s_nop 1
    v_add_f32_dpp v16, v13, v13 row_ror:1 row_mask:0xf bank_mask:0x2
    s_nop 1
    v_add_f32_dpp v16, v14, v14 row_ror:1 row_mask:0xf bank_mask:0x4
    s_nop 1
    v_add_f32_dpp v16, v15, v15 row_ror:1 row_mask:0xf bank_mask:0x8
    s_waitcnt vmcnt(4)
    buffer_load_dwordx4 v[144:147], v2, s[28:31], s56 offen offset:0 nt
    buffer_load_dwordx4 v[148:151], v2, s[28:31], s56 offen offset:1024 nt
    buffer_load_dwordx4 v[152:155], v2, s[28:31], s56 offen offset:2048 nt
    buffer_load_dwordx4 v[156:159], v2, s[28:31], s56 offen offset:3072 nt
    s_add_u32 s56, s56, 28672
    v_dot2_f32_bf16 v12, v240, v8, 0
    v_dot2_f32_bf16 v13, v244, v8, 0
    v_dot2_f32_bf16 v14, v248, v8, 0
    v_dot2_f32_bf16 v15, v252, v8, 0
    v_dot2_f32_bf16 v12, v241, v9, v12
    v_dot2_f32_bf16 v13, v245, v9, v13
    v_dot2_f32_bf16 v14, v249, v9, v14
    v_dot2_f32_bf16 v15, v253, v9, v15
    v_dot2_f32_bf16 v12, v242, v10, v12
    v_dot2_f32_bf16 v13, v246, v10, v13
    v_dot2_f32_bf16 v14, v250, v10, v14
    v_dot2_f32_bf16 v15, v254, v10, v15
    v_dot2_f32_bf16 v12, v243, v11, v12
    v_dot2_f32_bf16 v13, v247, v11, v13
    v_dot2_f32_bf16 v14, v251, v11, v14
    v_dot2_f32_bf16 v15, v255, v11, v15
    v_add_f32_dpp v12, v12, v12 row_ror:8 row_mask:0xf bank_mask:0xf
    v_add_f32_dpp v13, v13, v13 row_ror:8 row_mask:0xf bank_mask:0xf
    v_add_f32_dpp v14, v14, v14 row_ror:8 row_mask:0xf bank_mask:0xf
    v_add_f32_dpp v15, v15, v15 row_ror:8 row_mask:0xf bank_mask:0xf
    v_add_f32_dpp v12, v12, v12 row_ror:4 row_mask:0xf bank_mask:0xf
    v_add_f32_dpp v13, v13, v13 row_ror:4 row_mask:0xf bank_mask:0xf
    v_add_f32_dpp v14, v14, v14 row_ror:4 row_mask:0xf bank_mask:0xf
    v_add_f32_dpp v15, v15, v15 row_ror:4 row_mask:0xf bank_mask:0xf
    v_add_f32_dpp v12, v12, v12 row_ror:2 row_mask:0xf bank_mask:0xf
    v_add_f32_dpp v13, v13, v13 row_ror:2 row_mask:0xf bank_mask:0xf
    v_add_f32_dpp v14, v14, v14 row_ror:2 row_mask:0xf bank_mask:0xf
    v_add_f32_dpp v15, v15, v15 row_ror:2 row_mask:0xf bank_mask:0xf
    v_add_f32_dpp v17, v12, v12 row_ror:1 row_mask:0xf bank_mask:0x1
    s_nop 1
    v_add_f32_dpp v17, v13, v13 row_ror:1 row_mask:0xf bank_mask:0x2
    s_nop 1
    v_add_f32_dpp v17, v14, v14 row_ror:1 row_mask:0xf bank_mask:0x4
    s_nop 1
    v_add_f32_dpp v17, v15, v15 row_ror:1 row_mask:0xf bank_mask:0x8
    v_cvt_pk_bf16_f32 v18, v16, v17
    v_lshlrev_b32 v19, 16, v18
    v_and_b32 v20, s61, v18
    v_mul_f32 v19, s59, v19
    v_mul_f32 v20, s59, v20
    v_cvt_pk_bf16_f32 v18, v19, v20
    v_lshlrev_b32 v19, 16, v18
    v_and_b32 v20, s61, v18
    ds_write_b32 v4, v19 offset:1536
    ds_write_b32 v4, v20 offset:1552
    v_max3_f32 v24, v24, v19, v20
    v_add_u32 v4, 2048, v4
    s_sub_u32 s58, s58, 1
    s_cmp_lg_u32 s58, 0
    s_cbranch_scc1 L_kloop
    s_waitcnt vmcnt(4)
    buffer_load_dwordx4 v[160:163], v2, s[28:31], s56 offen offset:0 nt
    buffer_load_dwordx4 v[164:167], v2, s[28:31], s56 offen offset:1024 nt
    buffer_load_dwordx4 v[168:171], v2, s[28:31], s56 offen offset:2048 nt
    buffer_load_dwordx4 v[172:175], v2, s[28:31], s56 offen offset:3072 nt
    s_add_u32 s56, s56, 4096
    buffer_load_dwordx4 v[176:179], v2, s[28:31], s56 offen offset:0 nt
    buffer_load_dwordx4 v[180:183], v2, s[28:31], s56 offen offset:1024 nt
    buffer_load_dwordx4 v[184:187], v2, s[28:31], s56 offen offset:2048 nt
    buffer_load_dwordx4 v[188:191], v2, s[28:31], s56 offen offset:3072 nt
    s_add_u32 s56, s56, 28672
    buffer_load_dwordx4 v[192:195], v2, s[28:31], s56 offen offset:0 nt
    buffer_load_dwordx4 v[196:199], v2, s[28:31], s56 offen offset:1024 nt
    buffer_load_dwordx4 v[200:203], v2, s[28:31], s56 offen offset:2048 nt
    buffer_load_dwordx4 v[204:207], v2, s[28:31], s56 offen offset:3072 nt
    s_add_u32 s56, s56, 4096
    v_dot2_f32_bf16 v12, v128, v8, 0
    v_dot2_f32_bf16 v13, v132, v8, 0
    v_dot2_f32_bf16 v14, v136, v8, 0
    v_dot2_f32_bf16 v15, v140, v8, 0
    v_dot2_f32_bf16 v12, v129, v9, v12
    v_dot2_f32_bf16 v13, v133, v9, v13
    v_dot2_f32_bf16 v14, v137, v9, v14
    v_dot2_f32_bf16 v15, v141, v9, v15
    v_dot2_f32_bf16 v12, v130, v10, v12
    v_dot2_f32_bf16 v13, v134, v10, v13
    v_dot2_f32_bf16 v14, v138, v10, v14
    v_dot2_f32_bf16 v15, v142, v10, v15
    v_dot2_f32_bf16 v12, v131, v11, v12
    v_dot2_f32_bf16 v13, v135, v11, v13
    v_dot2_f32_bf16 v14, v139, v11, v14
    v_dot2_f32_bf16 v15, v143, v11, v15
    v_add_f32_dpp v12, v12, v12 row_ror:8 row_mask:0xf bank_mask:0xf
    v_add_f32_dpp v13, v13, v13 row_ror:8 row_mask:0xf bank_mask:0xf
    v_add_f32_dpp v14, v14, v14 row_ror:8 row_mask:0xf bank_mask:0xf
    v_add_f32_dpp v15, v15, v15 row_ror:8 row_mask:0xf bank_mask:0xf
    v_add_f32_dpp v12, v12, v12 row_ror:4 row_mask:0xf bank_mask:0xf
    v_add_f32_dpp v13, v13, v13 row_ror:4 row_mask:0xf bank_mask:0xf
    v_add_f32_dpp v14, v14, v14 row_ror:4 row_mask:0xf bank_mask:0xf
    v_add_f32_dpp v15, v15, v15 row_ror:4 row_mask:0xf bank_mask:0xf
    v_add_f32_dpp v12, v12, v12 row_ror:2 row_mask:0xf bank_mask:0xf
    v_add_f32_dpp v13, v13, v13 row_ror:2 row_mask:0xf bank_mask:0xf
    v_add_f32_dpp v14, v14, v14 row_ror:2 row_mask:0xf bank_mask:0xf
    v_add_f32_dpp v15, v15, v15 row_ror:2 row_mask:0xf bank_mask:0xf
    v_add_f32_dpp v16, v12, v12 row_ror:1 row_mask:0xf bank_mask:0x1
    s_nop 1
    v_add_f32_dpp v16, v13, v13 row_ror:1 row_mask:0xf bank_mask:0x2
    s_nop 1
    v_add_f32_dpp v16, v14, v14 row_ror:1 row_mask:0xf bank_mask:0x4
    s_nop 1
    v_add_f32_dpp v16, v15, v15 row_ror:1 row_mask:0xf bank_mask:0x8
    s_waitcnt vmcnt(12)
    buffer_load_dwordx4 v[208:211], v2, s[28:31], s56 offen offset:0 nt
    buffer_load_dwordx4 v[212:215], v2, s[28:31], s56 offen offset:1024 nt
    buffer_load_dwordx4 v[216:219], v2, s[28:31], s56 offen offset:2048 nt
    buffer_load_dwordx4 v[220:223], v2, s[28:31], s56 offen offset:3072 nt
    s_add_u32 s56, s56, 28672
    buffer_load_dwordx4 v[224:227], v2, s[28:31], s56 offen offset:0 nt
    buffer_load_dwordx4 v[228:231], v2, s[28:31], s56 offen offset:1024 nt
    buffer_load_dwordx4 v[232:235], v2, s[28:31], s56 offen offset:2048 nt
    buffer_load_dwordx4 v[236:239], v2, s[28:31], s56 offen offset:3072 nt
    s_add_u32 s56, s56, 4096
    buffer_load_dwordx4 v[240:243], v2, s[28:31], s56 offen offset:0 nt
    buffer_load_dwordx4 v[244:247], v2, s[28:31], s56 offen offset:1024 nt
    buffer_load_dwordx4 v[248:251], v2, s[28:31], s56 offen offset:2048 nt
    buffer_load_dwordx4 v[252:255], v2, s[28:31], s56 offen offset:3072 nt
    s_add_u32 s56, s56, 28672
    v_dot2_f32_bf16 v12, v144, v8, 0
    v_dot2_f32_bf16 v13, v148, v8, 0
    v_dot2_f32_bf16 v14, v152, v8, 0
    v_dot2_f32_bf16 v15, v156, v8, 0
    v_dot2_f32_bf16 v12, v145, v9, v12
    v_dot2_f32_bf16 v13, v149, v9, v13
    v_dot2_f32_bf16 v14, v153, v9, v14
    v_dot2_f32_bf16 v15, v157, v9, v15
    v_dot2_f32_bf16 v12, v146, v10, v12
    v_dot2_f32_bf16 v13, v150, v10, v13
    v_dot2_f32_bf16 v14, v154, v10, v14
    v_dot2_f32_bf16 v15, v158, v10, v15
    v_dot2_f32_bf16 v12, v147, v11, v12
    v_dot2_f32_bf16 v13, v151, v11, v13
    v_dot2_f32_bf16 v14, v155, v11, v14
    v_dot2_f32_bf16 v15, v159, v11, v15
    v_add_f32_dpp v12, v12, v12 row_ror:8 row_mask:0xf bank_mask:0xf
    v_add_f32_dpp v13, v13, v13 row_ror:8 row_mask:0xf bank_mask:0xf
    v_add_f32_dpp v14, v14, v14 row_ror:8 row_mask:0xf bank_mask:0xf
    v_add_f32_dpp v15, v15, v15 row_ror:8 row_mask:0xf bank_mask:0xf
    v_add_f32_dpp v12, v12, v12 row_ror:4 row_mask:0xf bank_mask:0xf
    v_add_f32_dpp v13, v13, v13 row_ror:4 row_mask:0xf bank_mask:0xf
    v_add_f32_dpp v14, v14, v14 row_ror:4 row_mask:0xf bank_mask:0xf
    v_add_f32_dpp v15, v15, v15 row_ror:4 row_mask:0xf bank_mask:0xf
    v_add_f32_dpp v12, v12, v12 row_ror:2 row_mask:0xf bank_mask:0xf
    v_add_f32_dpp v13, v13, v13 row_ror:2 row_mask:0xf bank_mask:0xf
    v_add_f32_dpp v14, v14, v14 row_ror:2 row_mask:0xf bank_mask:0xf
    v_add_f32_dpp v15, v15, v15 row_ror:2 row_mask:0xf bank_mask:0xf
    v_add_f32_dpp v17, v12, v12 row_ror:1 row_mask:0xf bank_mask:0x1
    s_nop 1
    v_add_f32_dpp v17, v13, v13 row_ror:1 row_mask:0xf bank_mask:0x2
    s_nop 1
    v_add_f32_dpp v17, v14, v14 row_ror:1 row_mask:0xf bank_mask:0x4
    s_nop 1
    v_add_f32_dpp v17, v15, v15 row_ror:1 row_mask:0xf bank_mask:0x8
    v_cvt_pk_bf16_f32 v18, v16, v17
    v_lshlrev_b32 v19, 16, v18
    v_and_b32 v20, s61, v18
    v_mul_f32 v19, s59, v19
    v_mul_f32 v20, s59, v20
    v_cvt_pk_bf16_f32 v18, v19, v20
    v_lshlrev_b32 v19, 16, v18
    v_and_b32 v20, s61, v18
    ds_write_b32 v4, v19 offset:0
    ds_write_b32 v4, v20 offset:16
    v_max3_f32 v24, v24, v19, v20
    s_waitcnt vmcnt(20)
    buffer_load_dwordx4 v[128:131], v2, s[32:35], s57 offen offset:0 nt
    buffer_load_dwordx4 v[132:135], v2, s[32:35], s57 offen offset:1024 nt
    buffer_load_dwordx4 v[136:139], v2, s[32:35], s57 offen offset:2048 nt
    buffer_load_dwordx4 v[140:143], v2, s[32:35], s57 offen offset:3072 nt
    s_add_u32 s57, s57, 4096
    buffer_load_dwordx4 v[144:147], v2, s[32:35], s57 offen offset:0 nt
    buffer_load_dwordx4 v[148:151], v2, s[32:35], s57 offen offset:1024 nt
    buffer_load_dwordx4 v[152:155], v2, s[32:35], s57 offen offset:2048 nt
    buffer_load_dwordx4 v[156:159], v2, s[32:35], s57 offen offset:3072 nt
    s_add_u32 s57, s57, 28672
    v_dot2_f32_bf16 v12, v160, v8, 0
    v_dot2_f32_bf16 v13, v164, v8, 0
    v_dot2_f32_bf16 v14, v168, v8, 0
    v_dot2_f32_bf16 v15, v172, v8, 0
    v_dot2_f32_bf16 v12, v161, v9, v12
    v_dot2_f32_bf16 v13, v165, v9, v13
    v_dot2_f32_bf16 v14, v169, v9, v14
    v_dot2_f32_bf16 v15, v173, v9, v15
    v_dot2_f32_bf16 v12, v162, v10, v12
    v_dot2_f32_bf16 v13, v166, v10, v13
    v_dot2_f32_bf16 v14, v170, v10, v14
    v_dot2_f32_bf16 v15, v174, v10, v15
    v_dot2_f32_bf16 v12, v163, v11, v12
    v_dot2_f32_bf16 v13, v167, v11, v13
    v_dot2_f32_bf16 v14, v171, v11, v14
    v_dot2_f32_bf16 v15, v175, v11, v15
    v_add_f32_dpp v12, v12, v12 row_ror:8 row_mask:0xf bank_mask:0xf
    v_add_f32_dpp v13, v13, v13 row_ror:8 row_mask:0xf bank_mask:0xf
    v_add_f32_dpp v14, v14, v14 row_ror:8 row_mask:0xf bank_mask:0xf
    v_add_f32_dpp v15, v15, v15 row_ror:8 row_mask:0xf bank_mask:0xf
    v_add_f32_dpp v12, v12, v12 row_ror:4 row_mask:0xf bank_mask:0xf
    v_add_f32_dpp v13, v13, v13 row_ror:4 row_mask:0xf bank_mask:0xf
    v_add_f32_dpp v14, v14, v14 row_ror:4 row_mask:0xf bank_mask:0xf
    v_add_f32_dpp v15, v15, v15 row_ror:4 row_mask:0xf bank_mask:0xf
    v_add_f32_dpp v12, v12, v12 row_ror:2 row_mask:0xf bank_mask:0xf
    v_add_f32_dpp v13, v13, v13 row_ror:2 row_mask:0xf bank_mask:0xf
    v_add_f32_dpp v14, v14, v14 row_ror:2 row_mask:0xf bank_mask:0xf
    v_add_f32_dpp v15, v15, v15 row_ror:2 row_mask:0xf bank_mask:0xf
    v_add_f32_dpp v16, v12, v12 row_ror:1 row_mask:0xf bank_mask:0x1
    s_nop 1
    v_add_f32_dpp v16, v13, v13 row_ror:1 row_mask:0xf bank_mask:0x2
    s_nop 1
    v_add_f32_dpp v16, v14, v14 row_ror:1 row_mask:0xf bank_mask:0x4
    s_nop 1
    v_add_f32_dpp v16, v15, v15 row_ror:1 row_mask:0xf bank_mask:0x8
    s_waitcnt vmcnt(24)
    buffer_load_dwordx4 v[160:163], v2, s[32:35], s57 offen offset:0 nt
    buffer_load_dwordx4 v[164:167], v2, s[32:35], s57 offen offset:1024 nt
    buffer_load_dwordx4 v[168:171], v2, s[32:35], s57 offen offset:2048 nt
    buffer_load_dwordx4 v[172:175], v2, s[32:35], s57 offen offset:3072 nt
    s_add_u32 s57, s57, 4096
    v_dot2_f32_bf16 v12, v176, v8, 0
    v_dot2_f32_bf16 v13, v180, v8, 0
    v_dot2_f32_bf16 v14, v184, v8, 0
    v_dot2_f32_bf16 v15, v188, v8, 0
    v_dot2_f32_bf16 v12, v177, v9, v12
    v_dot2_f32_bf16 v13, v181, v9, v13
    v_dot2_f32_bf16 v14, v185, v9, v14
    v_dot2_f32_bf16 v15, v189, v9, v15
    v_dot2_f32_bf16 v12, v178, v10, v12
    v_dot2_f32_bf16 v13, v182, v10, v13
    v_dot2_f32_bf16 v14, v186, v10, v14
    v_dot2_f32_bf16 v15, v190, v10, v15
    v_dot2_f32_bf16 v12, v179, v11, v12
    v_dot2_f32_bf16 v13, v183, v11, v13
    v_dot2_f32_bf16 v14, v187, v11, v14
    v_dot2_f32_bf16 v15, v191, v11, v15
    v_add_f32_dpp v12, v12, v12 row_ror:8 row_mask:0xf bank_mask:0xf
    v_add_f32_dpp v13, v13, v13 row_ror:8 row_mask:0xf bank_mask:0xf
    v_add_f32_dpp v14, v14, v14 row_ror:8 row_mask:0xf bank_mask:0xf
    v_add_f32_dpp v15, v15, v15 row_ror:8 row_mask:0xf bank_mask:0xf
    v_add_f32_dpp v12, v12, v12 row_ror:4 row_mask:0xf bank_mask:0xf
    v_add_f32_dpp v13, v13, v13 row_ror:4 row_mask:0xf bank_mask:0xf
    v_add_f32_dpp v14, v14, v14 row_ror:4 row_mask:0xf bank_mask:0xf
    v_add_f32_dpp v15, v15, v15 row_ror:4 row_mask:0xf bank_mask:0xf
    v_add_f32_dpp v12, v12, v12 row_ror:2 row_mask:0xf bank_mask:0xf
    v_add_f32_dpp v13, v13, v13 row_ror:2 row_mask:0xf bank_mask:0xf
    v_add_f32_dpp v14, v14, v14 row_ror:2 row_mask:0xf bank_mask:0xf
    v_add_f32_dpp v15, v15, v15 row_ror:2 row_mask:0xf bank_mask:0xf
    v_add_f32_dpp v17, v12, v12 row_ror:1 row_mask:0xf bank_mask:0x1
    s_nop 1
    v_add_f32_dpp v17, v13, v13 row_ror:1 row_mask:0xf bank_mask:0x2
    s_nop 1
    v_add_f32_dpp v17, v14, v14 row_ror:1 row_mask:0xf bank_mask:0x4
    s_nop 1
    v_add_f32_dpp v17, v15, v15 row_ror:1 row_mask:0xf bank_mask:0x8
    v_cvt_pk_bf16_f32 v18, v16, v17
    v_lshlrev_b32 v19, 16, v18
    v_and_b32 v20, s61, v18
    v_mul_f32 v19, s59, v19
    v_mul_f32 v20, s59, v20
    v_cvt_pk_bf16_f32 v18, v19, v20
    v_lshlrev_b32 v19, 16, v18
    v_and_b32 v20, s61, v18
    ds_write_b32 v4, v19 offset:512
    ds_write_b32 v4, v20 offset:528
    v_max3_f32 v24, v24, v19, v20
    s_waitcnt vmcnt(24)
    buffer_load_dwordx4 v[176:179], v2, s[32:35], s57 offen offset:0 nt
    buffer_load_dwordx4 v[180:183], v2, s[32:35], s57 offen offset:1024 nt
    buffer_load_dwordx4 v[184:187], v2, s[32:35], s57 offen offset:2048 nt
    buffer_load_dwordx4 v[188:191], v2, s[32:35], s57 offen offset:3072 nt
    s_add_u32 s57, s57, 28672
    v_dot2_f32_bf16 v12, v192, v8, 0
    v_dot2_f32_bf16 v13, v196, v8, 0
    v_dot2_f32_bf16 v14, v200, v8, 0
    v_dot2_f32_bf16 v15, v204, v8, 0
    v_dot2_f32_bf16 v12, v193, v9, v12
    v_dot2_f32_bf16 v13, v197, v9, v13
    v_dot2_f32_bf16 v14, v201, v9, v14
    v_dot2_f32_bf16 v15, v205, v9, v15
    v_dot2_f32_bf16 v12, v194, v10, v12
    v_dot2_f32_bf16 v13, v198, v10, v13
    v_dot2_f32_bf16 v14, v202, v10, v14
    v_dot2_f32_bf16 v15, v206, v10, v15
    v_dot2_f32_bf16 v12, v195, v11, v12
    v_dot2_f32_bf16 v13, v199, v11, v13
    v_dot2_f32_bf16 v14, v203, v11, v14
    v_dot2_f32_bf16 v15, v207, v11, v15
    v_add_f32_dpp v12, v12, v12 row_ror:8 row_mask:0xf bank_mask:0xf
    v_add_f32_dpp v13, v13, v13 row_ror:8 row_mask:0xf bank_mask:0xf
    v_add_f32_dpp v14, v14, v14 row_ror:8 row_mask:0xf bank_mask:0xf
    v_add_f32_dpp v15, v15, v15 row_ror:8 row_mask:0xf bank_mask:0xf
    v_add_f32_dpp v12, v12, v12 row_ror:4 row_mask:0xf bank_mask:0xf
    v_add_f32_dpp v13, v13, v13 row_ror:4 row_mask:0xf bank_mask:0xf
    v_add_f32_dpp v14, v14, v14 row_ror:4 row_mask:0xf bank_mask:0xf
    v_add_f32_dpp v15, v15, v15 row_ror:4 row_mask:0xf bank_mask:0xf
    v_add_f32_dpp v12, v12, v12 row_ror:2 row_mask:0xf bank_mask:0xf
    v_add_f32_dpp v13, v13, v13 row_ror:2 row_mask:0xf bank_mask:0xf
    v_add_f32_dpp v14, v14, v14 row_ror:2 row_mask:0xf bank_mask:0xf
    v_add_f32_dpp v15, v15, v15 row_ror:2 row_mask:0xf bank_mask:0xf
    v_add_f32_dpp v16, v12, v12 row_ror:1 row_mask:0xf bank_mask:0x1
    s_nop 1
    v_add_f32_dpp v16, v13, v13 row_ror:1 row_mask:0xf bank_mask:0x2
    s_nop 1
    v_add_f32_dpp v16, v14, v14 row_ror:1 row_mask:0xf bank_mask:0x4
    s_nop 1
    v_add_f32_dpp v16, v15, v15 row_ror:1 row_mask:0xf bank_mask:0x8
    s_waitcnt vmcnt(24)
    buffer_load_dwordx4 v[192:195], v2, s[32:35], s57 offen offset:0 nt
    buffer_load_dwordx4 v[196:199], v2, s[32:35], s57 offen offset:1024 nt
    buffer_load_dwordx4 v[200:203], v2, s[32:35], s57 offen offset:2048 nt
    buffer_load_dwordx4 v[204:207], v2, s[32:35], s57 offen offset:3072 nt
    s_add_u32 s57, s57, 4096
    v_dot2_f32_bf16 v12, v208, v8, 0
    v_dot2_f32_bf16 v13, v212, v8, 0
    v_dot2_f32_bf16 v14, v216, v8, 0
    v_dot2_f32_bf16 v15, v220, v8, 0
    v_dot2_f32_bf16 v12, v209, v9, v12
    v_dot2_f32_bf16 v13, v213, v9, v13
    v_dot2_f32_bf16 v14, v217, v9, v14
    v_dot2_f32_bf16 v15, v221, v9, v15
    v_dot2_f32_bf16 v12, v210, v10, v12
    v_dot2_f32_bf16 v13, v214, v10, v13
    v_dot2_f32_bf16 v14, v218, v10, v14
    v_dot2_f32_bf16 v15, v222, v10, v15
    v_dot2_f32_bf16 v12, v211, v11, v12
    v_dot2_f32_bf16 v13, v215, v11, v13
    v_dot2_f32_bf16 v14, v219, v11, v14
    v_dot2_f32_bf16 v15, v223, v11, v15
    v_add_f32_dpp v12, v12, v12 row_ror:8 row_mask:0xf bank_mask:0xf
    v_add_f32_dpp v13, v13, v13 row_ror:8 row_mask:0xf bank_mask:0xf
    v_add_f32_dpp v14, v14, v14 row_ror:8 row_mask:0xf bank_mask:0xf
    v_add_f32_dpp v15, v15, v15 row_ror:8 row_mask:0xf bank_mask:0xf
    v_add_f32_dpp v12, v12, v12 row_ror:4 row_mask:0xf bank_mask:0xf
    v_add_f32_dpp v13, v13, v13 row_ror:4 row_mask:0xf bank_mask:0xf
    v_add_f32_dpp v14, v14, v14 row_ror:4 row_mask:0xf bank_mask:0xf
    v_add_f32_dpp v15, v15, v15 row_ror:4 row_mask:0xf bank_mask:0xf
    v_add_f32_dpp v12, v12, v12 row_ror:2 row_mask:0xf bank_mask:0xf
    v_add_f32_dpp v13, v13, v13 row_ror:2 row_mask:0xf bank_mask:0xf
    v_add_f32_dpp v14, v14, v14 row_ror:2 row_mask:0xf bank_mask:0xf
    v_add_f32_dpp v15, v15, v15 row_ror:2 row_mask:0xf bank_mask:0xf
    v_add_f32_dpp v17, v12, v12 row_ror:1 row_mask:0xf bank_mask:0x1
    s_nop 1
    v_add_f32_dpp v17, v13, v13 row_ror:1 row_mask:0xf bank_mask:0x2
    s_nop 1
    v_add_f32_dpp v17, v14, v14 row_ror:1 row_mask:0xf bank_mask:0x4
    s_nop 1
    v_add_f32_dpp v17, v15, v15 row_ror:1 row_mask:0xf bank_mask:0x8
    v_cvt_pk_bf16_f32 v18, v16, v17
    v_lshlrev_b32 v19, 16, v18
    v_and_b32 v20, s61, v18
    v_mul_f32 v19, s59, v19
    v_mul_f32 v20, s59, v20
    v_cvt_pk_bf16_f32 v18, v19, v20
    v_lshlrev_b32 v19, 16, v18
    v_and_b32 v20, s61, v18
    ds_write_b32 v4, v19 offset:1024
    ds_write_b32 v4, v20 offset:1040
    v_max3_f32 v24, v24, v19, v20
    s_waitcnt vmcnt(24)
    buffer_load_dwordx4 v[208:211], v2, s[32:35], s57 offen offset:0 nt
    buffer_load_dwordx4 v[212:215], v2, s[32:35], s57 offen offset:1024 nt
    buffer_load_dwordx4 v[216:219], v2, s[32:35], s57 offen offset:2048 nt
    buffer_load_dwordx4 v[220:223], v2, s[32:35], s57 offen offset:3072 nt
    s_add_u32 s57, s57, 28672
    v_dot2_f32_bf16 v12, v224, v8, 0
    v_dot2_f32_bf16 v13, v228, v8, 0
    v_dot2_f32_bf16 v14, v232, v8, 0
    v_dot2_f32_bf16 v15, v236, v8, 0
    v_dot2_f32_bf16 v12, v225, v9, v12
    v_dot2_f32_bf16 v13, v229, v9, v13
    v_dot2_f32_bf16 v14, v233, v9, v14
    v_dot2_f32_bf16 v15, v237, v9, v15
    v_dot2_f32_bf16 v12, v226, v10, v12
    v_dot2_f32_bf16 v13, v230, v10, v13
    v_dot2_f32_bf16 v14, v234, v10, v14
    v_dot2_f32_bf16 v15, v238, v10, v15
    v_dot2_f32_bf16 v12, v227, v11, v12
    v_dot2_f32_bf16 v13, v231, v11, v13
    v_dot2_f32_bf16 v14, v235, v11, v14
    v_dot2_f32_bf16 v15, v239, v11, v15
    v_add_f32_dpp v12, v12, v12 row_ror:8 row_mask:0xf bank_mask:0xf
    v_add_f32_dpp v13, v13, v13 row_ror:8 row_mask:0xf bank_mask:0xf
    v_add_f32_dpp v14, v14, v14 row_ror:8 row_mask:0xf bank_mask:0xf
    v_add_f32_dpp v15, v15, v15 row_ror:8 row_mask:0xf bank_mask:0xf
    v_add_f32_dpp v12, v12, v12 row_ror:4 row_mask:0xf bank_mask:0xf
    v_add_f32_dpp v13, v13, v13 row_ror:4 row_mask:0xf bank_mask:0xf
    v_add_f32_dpp v14, v14, v14 row_ror:4 row_mask:0xf bank_mask:0xf
    v_add_f32_dpp v15, v15, v15 row_ror:4 row_mask:0xf bank_mask:0xf
    v_add_f32_dpp v12, v12, v12 row_ror:2 row_mask:0xf bank_mask:0xf
    v_add_f32_dpp v13, v13, v13 row_ror:2 row_mask:0xf bank_mask:0xf
    v_add_f32_dpp v14, v14, v14 row_ror:2 row_mask:0xf bank_mask:0xf
    v_add_f32_dpp v15, v15, v15 row_ror:2 row_mask:0xf bank_mask:0xf
    v_add_f32_dpp v16, v12, v12 row_ror:1 row_mask:0xf bank_mask:0x1
    s_nop 1
    v_add_f32_dpp v16, v13, v13 row_ror:1 row_mask:0xf bank_mask:0x2
    s_nop 1
    v_add_f32_dpp v16, v14, v14 row_ror:1 row_mask:0xf bank_mask:0x4
    s_nop 1
    v_add_f32_dpp v16, v15, v15 row_ror:1 row_mask:0xf bank_mask:0x8
    s_waitcnt vmcnt(24)
    buffer_load_dwordx4 v[224:227], v2, s[32:35], s57 offen offset:0 nt
    buffer_load_dwordx4 v[228:231], v2, s[32:35], s57 offen offset:1024 nt
    buffer_load_dwordx4 v[232:235], v2, s[32:35], s57 offen offset:2048 nt
    buffer_load_dwordx4 v[236:239], v2, s[32:35], s57 offen offset:3072 nt
    s_add_u32 s57, s57, 4096
    v_dot2_f32_bf16 v12, v240, v8, 0
    v_dot2_f32_bf16 v13, v244, v8, 0
    v_dot2_f32_bf16 v14, v248, v8, 0
    v_dot2_f32_bf16 v15, v252, v8, 0
    v_dot2_f32_bf16 v12, v241, v9, v12
    v_dot2_f32_bf16 v13, v245, v9, v13
    v_dot2_f32_bf16 v14, v249, v9, v14
    v_dot2_f32_bf16 v15, v253, v9, v15
    v_dot2_f32_bf16 v12, v242, v10, v12
    v_dot2_f32_bf16 v13, v246, v10, v13
    v_dot2_f32_bf16 v14, v250, v10, v14
    v_dot2_f32_bf16 v15, v254, v10, v15
    v_dot2_f32_bf16 v12, v243, v11, v12
    v_dot2_f32_bf16 v13, v247, v11, v13
    v_dot2_f32_bf16 v14, v251, v11, v14
    v_dot2_f32_bf16 v15, v255, v11, v15
    v_add_f32_dpp v12, v12, v12 row_ror:8 row_mask:0xf bank_mask:0xf
    v_add_f32_dpp v13, v13, v13 row_ror:8 row_mask:0xf bank_mask:0xf
    v_add_f32_dpp v14, v14, v14 row_ror:8 row_mask:0xf bank_mask:0xf
    v_add_f32_dpp v15, v15, v15 row_ror:8 row_mask:0xf bank_mask:0xf
    v_add_f32_dpp v12, v12, v12 row_ror:4 row_mask:0xf bank_mask:0xf
    v_add_f32_dpp v13, v13, v13 row_ror:4 row_mask:0xf bank_mask:0xf
    v_add_f32_dpp v14, v14, v14 row_ror:4 row_mask:0xf bank_mask:0xf
    v_add_f32_dpp v15, v15, v15 row_ror:4 row_mask:0xf bank_mask:0xf
    v_add_f32_dpp v12, v12, v12 row_ror:2 row_mask:0xf bank_mask:0xf
    v_add_f32_dpp v13, v13, v13 row_ror:2 row_mask:0xf bank_mask:0xf
    v_add_f32_dpp v14, v14, v14 row_ror:2 row_mask:0xf bank_mask:0xf
    v_add_f32_dpp v15, v15, v15 row_ror:2 row_mask:0xf bank_mask:0xf
    v_add_f32_dpp v17, v12, v12 row_ror:1 row_mask:0xf bank_mask:0x1
    s_nop 1
    v_add_f32_dpp v17, v13, v13 row_ror:1 row_mask:0xf bank_mask:0x2
    s_nop 1
    v_add_f32_dpp v17, v14, v14 row_ror:1 row_mask:0xf bank_mask:0x4
    s_nop 1
    v_add_f32_dpp v17, v15, v15 row_ror:1 row_mask:0xf bank_mask:0x8
    v_cvt_pk_bf16_f32 v18, v16, v17
    v_lshlrev_b32 v19, 16, v18
    v_and_b32 v20, s61, v18
    v_mul_f32 v19, s59, v19
    v_mul_f32 v20, s59, v20
    v_cvt_pk_bf16_f32 v18, v19, v20
    v_lshlrev_b32 v19, 16, v18
    v_and_b32 v20, s61, v18
    ds_write_b32 v4, v19 offset:1536
    ds_write_b32 v4, v20 offset:1552
    v_max3_f32 v24, v24, v19, v20
    v_add_u32 v4, 2048, v4
    buffer_load_dwordx4 v[240:243], v2, s[32:35], s57 offen offset:0 nt
    buffer_load_dwordx4 v[244:247], v2, s[32:35], s57 offen offset:1024 nt
    buffer_load_dwordx4 v[248:251], v2, s[32:35], s57 offen offset:2048 nt
    buffer_load_dwordx4 v[252:255], v2, s[32:35], s57 offen offset:3072 nt
    s_add_u32 s57, s57, 28672
    v_max_f32_dpp v24, v24, v24 row_ror:4 row_mask:0xf bank_mask:0xf
    s_nop 1
    v_max_f32_dpp v24, v24, v24 row_ror:8 row_mask:0xf bank_mask:0xf
    v_mov_b32 v18, v24
    s_nop 1
    v_permlane16_swap_b32 v24, v18
    v_max_f32 v24, v24, v18
    v_mov_b32 v18, v24
    s_nop 1
    v_permlane32_swap_b32 v24, v18
    v_max_f32 v24, v24, v18
    s_lshl_b32 s52, s44, 2
    v_mov_b32 v18, s52
    ds_write_b32 v18, v24 offset:24576
    s_waitcnt lgkmcnt(0)
    s_barrier
    v_lshlrev_b32 v72, 5, v0
    v_mov_b32 v73, 0
    ds_read_b128 v[64:67], v72 offset:0
    ds_read_b128 v[68:71], v72 offset:16
    ds_read_b128 v[76:79], v73 offset:24576
    s_waitcnt lgkmcnt(0)
    v_max_f32 v76, v76, v77
    v_max3_f32 v76, v76, v78, v79
    v_sub_f32 v64, v64, v76
    v_sub_f32 v65, v65, v76
    v_sub_f32 v66, v66, v76
    v_sub_f32 v67, v67, v76
    v_sub_f32 v68, v68, v76
    v_sub_f32 v69, v69, v76
    v_sub_f32 v70, v70, v76
    v_sub_f32 v71, v71, v76
    v_mul_f32 v64, s60, v64
    v_mul_f32 v65, s60, v65
    v_mul_f32 v66, s60, v66
    v_mul_f32 v67, s60, v67
    v_mul_f32 v68, s60, v68
    v_mul_f32 v69, s60, v69
    v_mul_f32 v70, s60, v70
    v_mul_f32 v71, s60, v71
    v_exp_f32 v64, v64
    v_exp_f32 v65, v65
    v_exp_f32 v66, v66
    v_exp_f32 v67, v67
    v_exp_f32 v68, v68
    v_exp_f32 v69, v69
    v_exp_f32 v70, v70
    v_exp_f32 v71, v71
    v_add_f32 v74, v64, v65
    v_add_f32 v74, v74, v66
    v_add_f32 v74, v74, v67
    v_add_f32 v74, v74, v68
    v_add_f32 v74, v74, v69
    v_add_f32 v74, v74, v70
    v_add_f32 v74, v74, v71
    s_nop 1
    v_add_f32_dpp v74, v74, v74 row_ror:8 row_mask:0xf bank_mask:0xf
    s_nop 1
    v_add_f32_dpp v74, v74, v74 row_ror:4 row_mask:0xf bank_mask:0xf
    s_nop 1
    v_add_f32_dpp v74, v74, v74 row_ror:2 row_mask:0xf bank_mask:0xf
    s_nop 1
    v_add_f32_dpp v74, v74, v74 row_ror:1 row_mask:0xf bank_mask:0xf
    v_mov_b32 v75, v74
    s_nop 1
    v_permlane16_swap_b32 v74, v75
    v_add_f32 v74, v74, v75
    v_mov_b32 v75, v74
    s_nop 1
    v_permlane32_swap_b32 v74, v75
    v_add_f32 v74, v74, v75
    s_lshl_b32 s52, s44, 2
    v_mov_b32 v75, s52
    ds_write_b32 v75, v74 offset:24608
    s_waitcnt lgkmcnt(0)
    s_barrier
    s_barrier
    ds_read_b32 v74, v73 offset:24640
    s_waitcnt lgkmcnt(0)
    v_mul_f32 v64, v64, v74
    v_mul_f32 v65, v65, v74
    v_mul_f32 v66, v66, v74
    v_mul_f32 v67, v67, v74
    v_mul_f32 v68, v68, v74
    v_mul_f32 v69, v69, v74
    v_mul_f32 v70, v70, v74
    v_mul_f32 v71, v71, v74
    v_cvt_pk_bf16_f32 v75, v64, v65
    v_lshlrev_b32 v64, 16, v75
    v_and_b32 v65, s61, v75
    v_cvt_pk_bf16_f32 v75, v66, v67
    v_lshlrev_b32 v66, 16, v75
    v_and_b32 v67, s61, v75
    v_cvt_pk_bf16_f32 v75, v68, v69
    v_lshlrev_b32 v68, 16, v75
    v_and_b32 v69, s61, v75
    v_cvt_pk_bf16_f32 v75, v70, v71
    v_lshlrev_b32 v70, 16, v75
    v_and_b32 v71, s61, v75
    ds_write_b128 v72, v[64:67] offset:0
    ds_write_b128 v72, v[68:71] offset:16
    s_waitcnt lgkmcnt(0)
    s_barrier
    ds_read_b128 v[40:43], v3 offset:0
    ds_read_b128 v[44:47], v3 offset:16
    v_mov_b32 v58, 93952
    v_mov_b32 v64, v3
    v_lshl_add_u32 v31, v5, 2, v7
    s_mov_b32 s68, s45
    s_mov_b32 s69, s45
    s_lshl_b32 s70, s44, 13
    s_waitcnt lgkmcnt(0)
    s_waitcnt vmcnt(28)
    v_lshrrev_b32 v56, 16, v40
    v_dot2c_f32_bf16 v33, v128, v40
    v_dot2c_f32_bf16 v35, v129, v40
    v_dot2c_f32_bf16 v37, v130, v40
    v_dot2c_f32_bf16 v39, v131, v40
    v_dot2c_f32_bf16 v32, v128, v56
    v_dot2c_f32_bf16 v34, v129, v56
    v_dot2c_f32_bf16 v36, v130, v56
    v_dot2c_f32_bf16 v38, v131, v56
    v_lshrrev_b32 v57, 16, v41
    v_dot2c_f32_bf16 v33, v132, v41
    v_dot2c_f32_bf16 v35, v133, v41
    v_dot2c_f32_bf16 v37, v134, v41
    v_dot2c_f32_bf16 v39, v135, v41
    v_dot2c_f32_bf16 v32, v132, v57
    v_dot2c_f32_bf16 v34, v133, v57
    v_dot2c_f32_bf16 v36, v134, v57
    v_dot2c_f32_bf16 v38, v135, v57
    v_lshrrev_b32 v56, 16, v42
    v_dot2c_f32_bf16 v33, v136, v42
    v_dot2c_f32_bf16 v35, v137, v42
    v_dot2c_f32_bf16 v37, v138, v42
    v_dot2c_f32_bf16 v39, v139, v42
    v_dot2c_f32_bf16 v32, v136, v56
    v_dot2c_f32_bf16 v34, v137, v56
    v_dot2c_f32_bf16 v36, v138, v56
    v_dot2c_f32_bf16 v38, v139, v56
    v_lshrrev_b32 v57, 16, v43
    v_dot2c_f32_bf16 v33, v140, v43
    v_dot2c_f32_bf16 v35, v141, v43
    v_dot2c_f32_bf16 v37, v142, v43
    v_dot2c_f32_bf16 v39, v143, v43
    v_dot2c_f32_bf16 v32, v140, v57
    v_dot2c_f32_bf16 v34, v141, v57
    v_dot2c_f32_bf16 v36, v142, v57
    v_dot2c_f32_bf16 v38, v143, v57
    ds_read_b128 v[48:51], v3 offset:512
    ds_read_b128 v[52:55], v3 offset:528
    s_waitcnt vmcnt(24)
    v_lshrrev_b32 v56, 16, v44
    v_dot2c_f32_bf16 v33, v144, v44
    v_dot2c_f32_bf16 v35, v145, v44
    v_dot2c_f32_bf16 v37, v146, v44
    v_dot2c_f32_bf16 v39, v147, v44
    v_dot2c_f32_bf16 v32, v144, v56
    v_dot2c_f32_bf16 v34, v145, v56
    v_dot2c_f32_bf16 v36, v146, v56
    v_dot2c_f32_bf16 v38, v147, v56
    v_lshrrev_b32 v57, 16, v45
    v_dot2c_f32_bf16 v33, v148, v45
    v_dot2c_f32_bf16 v35, v149, v45
    v_dot2c_f32_bf16 v37, v150, v45
    v_dot2c_f32_bf16 v39, v151, v45
    v_dot2c_f32_bf16 v32, v148, v57
    v_dot2c_f32_bf16 v34, v149, v57
    v_dot2c_f32_bf16 v36, v150, v57
    v_dot2c_f32_bf16 v38, v151, v57
    v_lshrrev_b32 v56, 16, v46
    v_dot2c_f32_bf16 v33, v152, v46
    v_dot2c_f32_bf16 v35, v153, v46
    v_dot2c_f32_bf16 v37, v154, v46
    v_dot2c_f32_bf16 v39, v155, v46
    v_dot2c_f32_bf16 v32, v152, v56
    v_dot2c_f32_bf16 v34, v153, v56
    v_dot2c_f32_bf16 v36, v154, v56
    v_dot2c_f32_bf16 v38, v155, v56
    v_lshrrev_b32 v57, 16, v47
    v_dot2c_f32_bf16 v33, v156, v47
    v_dot2c_f32_bf16 v35, v157, v47
    v_dot2c_f32_bf16 v37, v158, v47
    v_dot2c_f32_bf16 v39, v159, v47
    v_dot2c_f32_bf16 v32, v156, v57
    v_dot2c_f32_bf16 v34, v157, v57
    v_dot2c_f32_bf16 v36, v158, v57
    v_dot2c_f32_bf16 v38, v159, v57
    s_waitcnt lgkmcnt(0)
    s_waitcnt vmcnt(20)
    v_lshrrev_b32 v56, 16, v48
    v_dot2c_f32_bf16 v33, v160, v48
    v_dot2c_f32_bf16 v35, v161, v48
    v_dot2c_f32_bf16 v37, v162, v48
    v_dot2c_f32_bf16 v39, v163, v48
    v_dot2c_f32_bf16 v32, v160, v56
    v_dot2c_f32_bf16 v34, v161, v56
    v_dot2c_f32_bf16 v36, v162, v56
    v_dot2c_f32_bf16 v38, v163, v56
    v_lshrrev_b32 v57, 16, v49
    v_dot2c_f32_bf16 v33, v164, v49
    v_dot2c_f32_bf16 v35, v165, v49
    v_dot2c_f32_bf16 v37, v166, v49
    v_dot2c_f32_bf16 v39, v167, v49
    v_dot2c_f32_bf16 v32, v164, v57
    v_dot2c_f32_bf16 v34, v165, v57
    v_dot2c_f32_bf16 v36, v166, v57
    v_dot2c_f32_bf16 v38, v167, v57
    v_lshrrev_b32 v56, 16, v50
    v_dot2c_f32_bf16 v33, v168, v50
    v_dot2c_f32_bf16 v35, v169, v50
    v_dot2c_f32_bf16 v37, v170, v50
    v_dot2c_f32_bf16 v39, v171, v50
    v_dot2c_f32_bf16 v32, v168, v56
    v_dot2c_f32_bf16 v34, v169, v56
    v_dot2c_f32_bf16 v36, v170, v56
    v_dot2c_f32_bf16 v38, v171, v56
    v_lshrrev_b32 v57, 16, v51
    v_dot2c_f32_bf16 v33, v172, v51
    v_dot2c_f32_bf16 v35, v173, v51
    v_dot2c_f32_bf16 v37, v174, v51
    v_dot2c_f32_bf16 v39, v175, v51
    v_dot2c_f32_bf16 v32, v172, v57
    v_dot2c_f32_bf16 v34, v173, v57
    v_dot2c_f32_bf16 v36, v174, v57
    v_dot2c_f32_bf16 v38, v175, v57
    ds_read_b128 v[40:43], v3 offset:1024
    ds_read_b128 v[44:47], v3 offset:1040
    s_waitcnt vmcnt(16)
    v_lshrrev_b32 v56, 16, v52
    v_dot2c_f32_bf16 v33, v176, v52
    v_dot2c_f32_bf16 v35, v177, v52
    v_dot2c_f32_bf16 v37, v178, v52
    v_dot2c_f32_bf16 v39, v179, v52
    v_dot2c_f32_bf16 v32, v176, v56
    v_dot2c_f32_bf16 v34, v177, v56
    v_dot2c_f32_bf16 v36, v178, v56
    v_dot2c_f32_bf16 v38, v179, v56
    v_lshrrev_b32 v57, 16, v53
    v_dot2c_f32_bf16 v33, v180, v53
    v_dot2c_f32_bf16 v35, v181, v53
    v_dot2c_f32_bf16 v37, v182, v53
    v_dot2c_f32_bf16 v39, v183, v53
    v_dot2c_f32_bf16 v32, v180, v57
    v_dot2c_f32_bf16 v34, v181, v57
    v_dot2c_f32_bf16 v36, v182, v57
    v_dot2c_f32_bf16 v38, v183, v57
    v_lshrrev_b32 v56, 16, v54
    v_dot2c_f32_bf16 v33, v184, v54
    v_dot2c_f32_bf16 v35, v185, v54
    v_dot2c_f32_bf16 v37, v186, v54
    v_dot2c_f32_bf16 v39, v187, v54
    v_dot2c_f32_bf16 v32, v184, v56
    v_dot2c_f32_bf16 v34, v185, v56
    v_dot2c_f32_bf16 v36, v186, v56
    v_dot2c_f32_bf16 v38, v187, v56
    v_lshrrev_b32 v57, 16, v55
    v_dot2c_f32_bf16 v33, v188, v55
    v_dot2c_f32_bf16 v35, v189, v55
    v_dot2c_f32_bf16 v37, v190, v55
    v_dot2c_f32_bf16 v39, v191, v55
    v_dot2c_f32_bf16 v32, v188, v57
    v_dot2c_f32_bf16 v34, v189, v57
    v_dot2c_f32_bf16 v36, v190, v57
    v_dot2c_f32_bf16 v38, v191, v57
    s_waitcnt lgkmcnt(0)
    s_waitcnt vmcnt(12)
    v_lshrrev_b32 v56, 16, v40
    v_dot2c_f32_bf16 v33, v192, v40
    v_dot2c_f32_bf16 v35, v193, v40
    v_dot2c_f32_bf16 v37, v194, v40
    v_dot2c_f32_bf16 v39, v195, v40
    v_dot2c_f32_bf16 v32, v192, v56
    v_dot2c_f32_bf16 v34, v193, v56
    v_dot2c_f32_bf16 v36, v194, v56
    v_dot2c_f32_bf16 v38, v195, v56
    v_lshrrev_b32 v57, 16, v41
    v_dot2c_f32_bf16 v33, v196, v41
    v_dot2c_f32_bf16 v35, v197, v41
    v_dot2c_f32_bf16 v37, v198, v41
    v_dot2c_f32_bf16 v39, v199, v41
    v_dot2c_f32_bf16 v32, v196, v57
    v_dot2c_f32_bf16 v34, v197, v57
    v_dot2c_f32_bf16 v36, v198, v57
    v_dot2c_f32_bf16 v38, v199, v57
    v_lshrrev_b32 v56, 16, v42
    v_dot2c_f32_bf16 v33, v200, v42
    v_dot2c_f32_bf16 v35, v201, v42
    v_dot2c_f32_bf16 v37, v202, v42
    v_dot2c_f32_bf16 v39, v203, v42
    v_dot2c_f32_bf16 v32, v200, v56
    v_dot2c_f32_bf16 v34, v201, v56
    v_dot2c_f32_bf16 v36, v202, v56
    v_dot2c_f32_bf16 v38, v203, v56
    v_lshrrev_b32 v57, 16, v43
    v_dot2c_f32_bf16 v33, v204, v43
    v_dot2c_f32_bf16 v35, v205, v43
    v_dot2c_f32_bf16 v37, v206, v43
    v_dot2c_f32_bf16 v39, v207, v43
    v_dot2c_f32_bf16 v32, v204, v57
    v_dot2c_f32_bf16 v34, v205, v57
    v_dot2c_f32_bf16 v36, v206, v57
    v_dot2c_f32_bf16 v38, v207, v57
    ds_read_b128 v[48:51], v3 offset:1536
    ds_read_b128 v[52:55], v3 offset:1552
    s_waitcnt vmcnt(8)
    v_lshrrev_b32 v56, 16, v44
    v_dot2c_f32_bf16 v33, v208, v44
    v_dot2c_f32_bf16 v35, v209, v44
    v_dot2c_f32_bf16 v37, v210, v44
    v_dot2c_f32_bf16 v39, v211, v44
    v_dot2c_f32_bf16 v32, v208, v56
    v_dot2c_f32_bf16 v34, v209, v56
    v_dot2c_f32_bf16 v36, v210, v56
    v_dot2c_f32_bf16 v38, v211, v56
    v_lshrrev_b32 v57, 16, v45
    v_dot2c_f32_bf16 v33, v212, v45
    v_dot2c_f32_bf16 v35, v213, v45
    v_dot2c_f32_bf16 v37, v214, v45
    v_dot2c_f32_bf16 v39, v215, v45
    v_dot2c_f32_bf16 v32, v212, v57
    v_dot2c_f32_bf16 v34, v213, v57
    v_dot2c_f32_bf16 v36, v214, v57
    v_dot2c_f32_bf16 v38, v215, v57
    v_lshrrev_b32 v56, 16, v46
    v_dot2c_f32_bf16 v33, v216, v46
    v_dot2c_f32_bf16 v35, v217, v46
    v_dot2c_f32_bf16 v37, v218, v46
    v_dot2c_f32_bf16 v39, v219, v46
    v_dot2c_f32_bf16 v32, v216, v56
    v_dot2c_f32_bf16 v34, v217, v56
    v_dot2c_f32_bf16 v36, v218, v56
    v_dot2c_f32_bf16 v38, v219, v56
    v_lshrrev_b32 v57, 16, v47
    v_dot2c_f32_bf16 v33, v220, v47
    v_dot2c_f32_bf16 v35, v221, v47
    v_dot2c_f32_bf16 v37, v222, v47
    v_dot2c_f32_bf16 v39, v223, v47
    v_dot2c_f32_bf16 v32, v220, v57
    v_dot2c_f32_bf16 v34, v221, v57
    v_dot2c_f32_bf16 v36, v222, v57
    v_dot2c_f32_bf16 v38, v223, v57
    s_waitcnt lgkmcnt(0)
    s_waitcnt vmcnt(4)
    buffer_load_dwordx4 v[128:131], v2, s[32:35], s57 offen offset:0 nt
    buffer_load_dwordx4 v[132:135], v2, s[32:35], s57 offen offset:1024 nt
    buffer_load_dwordx4 v[136:139], v2, s[32:35], s57 offen offset:2048 nt
    buffer_load_dwordx4 v[140:143], v2, s[32:35], s57 offen offset:3072 nt
    s_add_u32 s57, s57, 4096
    v_lshrrev_b32 v56, 16, v48
    v_dot2c_f32_bf16 v33, v224, v48
    v_dot2c_f32_bf16 v35, v225, v48
    v_dot2c_f32_bf16 v37, v226, v48
    v_dot2c_f32_bf16 v39, v227, v48
    v_dot2c_f32_bf16 v32, v224, v56
    v_dot2c_f32_bf16 v34, v225, v56
    v_dot2c_f32_bf16 v36, v226, v56
    v_dot2c_f32_bf16 v38, v227, v56
    v_lshrrev_b32 v57, 16, v49
    v_dot2c_f32_bf16 v33, v228, v49
    v_dot2c_f32_bf16 v35, v229, v49
    v_dot2c_f32_bf16 v37, v230, v49
    v_dot2c_f32_bf16 v39, v231, v49
    v_dot2c_f32_bf16 v32, v228, v57
    v_dot2c_f32_bf16 v34, v229, v57
    v_dot2c_f32_bf16 v36, v230, v57
    v_dot2c_f32_bf16 v38, v231, v57
    v_lshrrev_b32 v56, 16, v50
    v_dot2c_f32_bf16 v33, v232, v50
    v_dot2c_f32_bf16 v35, v233, v50
    v_dot2c_f32_bf16 v37, v234, v50
    v_dot2c_f32_bf16 v39, v235, v50
    v_dot2c_f32_bf16 v32, v232, v56
    v_dot2c_f32_bf16 v34, v233, v56
    v_dot2c_f32_bf16 v36, v234, v56
    v_dot2c_f32_bf16 v38, v235, v56
    v_lshrrev_b32 v57, 16, v51
    v_dot2c_f32_bf16 v33, v236, v51
    v_dot2c_f32_bf16 v35, v237, v51
    v_dot2c_f32_bf16 v37, v238, v51
    v_dot2c_f32_bf16 v39, v239, v51
    v_dot2c_f32_bf16 v32, v236, v57
    v_dot2c_f32_bf16 v34, v237, v57
    v_dot2c_f32_bf16 v36, v238, v57
    v_dot2c_f32_bf16 v38, v239, v57
    v_add_u32 v3, 2048, v3
    ds_read_b128 v[40:43], v3 offset:0
    ds_read_b128 v[44:47], v3 offset:16
    s_waitcnt vmcnt(4)
    buffer_load_dwordx4 v[144:147], v2, s[32:35], s57 offen offset:0 nt
    buffer_load_dwordx4 v[148:151], v2, s[32:35], s57 offen offset:1024 nt
    buffer_load_dwordx4 v[152:155], v2, s[32:35], s57 offen offset:2048 nt
    buffer_load_dwordx4 v[156:159], v2, s[32:35], s57 offen offset:3072 nt
    s_add_u32 s57, s57, 28672
    v_lshrrev_b32 v56, 16, v52
    v_dot2c_f32_bf16 v33, v240, v52
    v_dot2c_f32_bf16 v35, v241, v52
    v_dot2c_f32_bf16 v37, v242, v52
    v_dot2c_f32_bf16 v39, v243, v52
    v_dot2c_f32_bf16 v32, v240, v56
    v_dot2c_f32_bf16 v34, v241, v56
    v_dot2c_f32_bf16 v36, v242, v56
    v_dot2c_f32_bf16 v38, v243, v56
    v_lshrrev_b32 v57, 16, v53
    v_dot2c_f32_bf16 v33, v244, v53
    v_dot2c_f32_bf16 v35, v245, v53
    v_dot2c_f32_bf16 v37, v246, v53
    v_dot2c_f32_bf16 v39, v247, v53
    v_dot2c_f32_bf16 v32, v244, v57
    v_dot2c_f32_bf16 v34, v245, v57
    v_dot2c_f32_bf16 v36, v246, v57
    v_dot2c_f32_bf16 v38, v247, v57
    v_lshrrev_b32 v56, 16, v54
    v_dot2c_f32_bf16 v33, v248, v54
    v_dot2c_f32_bf16 v35, v249, v54
    v_dot2c_f32_bf16 v37, v250, v54
    v_dot2c_f32_bf16 v39, v251, v54
    v_dot2c_f32_bf16 v32, v248, v56
    v_dot2c_f32_bf16 v34, v249, v56
    v_dot2c_f32_bf16 v36, v250, v56
    v_dot2c_f32_bf16 v38, v251, v56
    v_lshrrev_b32 v57, 16, v55
    v_dot2c_f32_bf16 v33, v252, v55
    v_dot2c_f32_bf16 v35, v253, v55
    v_dot2c_f32_bf16 v37, v254, v55
    v_dot2c_f32_bf16 v39, v255, v55
    v_dot2c_f32_bf16 v32, v252, v57
    v_dot2c_f32_bf16 v34, v253, v57
    v_dot2c_f32_bf16 v36, v254, v57
    v_dot2c_f32_bf16 v38, v255, v57
    ds_read_b128 v[60:63], v58
L_row0:
    s_waitcnt lgkmcnt(0)
    v_readfirstlane_b32 s64, v60
    v_readfirstlane_b32 s66, v61
    v_readfirstlane_b32 s67, v62
    s_cmp_ge_u32 s64, -2
    s_cbranch_scc1 L_odd0
    v_add_u32 v58, 16, v58
    s_add_u32 s57, s64, s70
    v_add_u32 v59, s66, v64
    ds_read_b128 v[60:63], v58
    s_waitcnt vmcnt(4)
    buffer_load_dwordx4 v[160:163], v2, s[32:35], s57 offen offset:0 nt
    buffer_load_dwordx4 v[164:167], v2, s[32:35], s57 offen offset:1024 nt
    buffer_load_dwordx4 v[168:171], v2, s[32:35], s57 offen offset:2048 nt
    buffer_load_dwordx4 v[172:175], v2, s[32:35], s57 offen offset:3072 nt
    s_add_u32 s57, s57, 4096
    s_cmp_lg_u32 s68, s69
    s_cbranch_scc1 L_flush0
L_fback0:
    v_lshrrev_b32 v56, 16, v40
    v_dot2c_f32_bf16 v33, v128, v40
    v_dot2c_f32_bf16 v35, v129, v40
    v_dot2c_f32_bf16 v37, v130, v40
    v_dot2c_f32_bf16 v39, v131, v40
    v_dot2c_f32_bf16 v32, v128, v56
    v_dot2c_f32_bf16 v34, v129, v56
    v_dot2c_f32_bf16 v36, v130, v56
    v_dot2c_f32_bf16 v38, v131, v56
    v_lshrrev_b32 v57, 16, v41
    v_dot2c_f32_bf16 v33, v132, v41
    v_dot2c_f32_bf16 v35, v133, v41
    v_dot2c_f32_bf16 v37, v134, v41
    v_dot2c_f32_bf16 v39, v135, v41
    v_dot2c_f32_bf16 v32, v132, v57
    v_dot2c_f32_bf16 v34, v133, v57
    v_dot2c_f32_bf16 v36, v134, v57
    v_dot2c_f32_bf16 v38, v135, v57
    v_lshrrev_b32 v56, 16, v42
    v_dot2c_f32_bf16 v33, v136, v42
    v_dot2c_f32_bf16 v35, v137, v42
    v_dot2c_f32_bf16 v37, v138, v42
    v_dot2c_f32_bf16 v39, v139, v42
    v_dot2c_f32_bf16 v32, v136, v56
    v_dot2c_f32_bf16 v34, v137, v56
    v_dot2c_f32_bf16 v36, v138, v56
    v_dot2c_f32_bf16 v38, v139, v56
    v_lshrrev_b32 v57, 16, v43
    v_dot2c_f32_bf16 v33, v140, v43
    v_dot2c_f32_bf16 v35, v141, v43
    v_dot2c_f32_bf16 v37, v142, v43
    v_dot2c_f32_bf16 v39, v143, v43
    v_dot2c_f32_bf16 v32, v140, v57
    v_dot2c_f32_bf16 v34, v141, v57
    v_dot2c_f32_bf16 v36, v142, v57
    v_dot2c_f32_bf16 v38, v143, v57
    ds_read_b128 v[48:51], v59
    ds_read_b128 v[52:55], v59 offset:16
    s_waitcnt vmcnt(4)
    buffer_load_dwordx4 v[176:179], v2, s[32:35], s57 offen offset:0 nt
    buffer_load_dwordx4 v[180:183], v2, s[32:35], s57 offen offset:1024 nt
    buffer_load_dwordx4 v[184:187], v2, s[32:35], s57 offen offset:2048 nt
    buffer_load_dwordx4 v[188:191], v2, s[32:35], s57 offen offset:3072 nt
    v_lshrrev_b32 v56, 16, v44
    v_dot2c_f32_bf16 v33, v144, v44
    v_dot2c_f32_bf16 v35, v145, v44
    v_dot2c_f32_bf16 v37, v146, v44
    v_dot2c_f32_bf16 v39, v147, v44
    v_dot2c_f32_bf16 v32, v144, v56
    v_dot2c_f32_bf16 v34, v145, v56
    v_dot2c_f32_bf16 v36, v146, v56
    v_dot2c_f32_bf16 v38, v147, v56
    v_lshrrev_b32 v57, 16, v45
    v_dot2c_f32_bf16 v33, v148, v45
    v_dot2c_f32_bf16 v35, v149, v45
    v_dot2c_f32_bf16 v37, v150, v45
    v_dot2c_f32_bf16 v39, v151, v45
    v_dot2c_f32_bf16 v32, v148, v57
    v_dot2c_f32_bf16 v34, v149, v57
    v_dot2c_f32_bf16 v36, v150, v57
    v_dot2c_f32_bf16 v38, v151, v57
    v_lshrrev_b32 v56, 16, v46
    v_dot2c_f32_bf16 v33, v152, v46
    v_dot2c_f32_bf16 v35, v153, v46
    v_dot2c_f32_bf16 v37, v154, v46
    v_dot2c_f32_bf16 v39, v155, v46
    v_dot2c_f32_bf16 v32, v152, v56
    v_dot2c_f32_bf16 v34, v153, v56
    v_dot2c_f32_bf16 v36, v154, v56
    v_dot2c_f32_bf16 v38, v155, v56
    v_lshrrev_b32 v57, 16, v47
    v_dot2c_f32_bf16 v33, v156, v47
    v_dot2c_f32_bf16 v35, v157, v47
    v_dot2c_f32_bf16 v37, v158, v47
    v_dot2c_f32_bf16 v39, v159, v47
    v_dot2c_f32_bf16 v32, v156, v57
    v_dot2c_f32_bf16 v34, v157, v57
    v_dot2c_f32_bf16 v36, v158, v57
    v_dot2c_f32_bf16 v38, v159, v57
    s_mov_b32 s68, s67
L_row1:
    s_waitcnt lgkmcnt(0)
    v_readfirstlane_b32 s64, v60
    v_readfirstlane_b32 s66, v61
    v_readfirstlane_b32 s67, v62
    s_cmp_ge_u32 s64, -2
    s_cbranch_scc1 L_odd1
    v_add_u32 v58, 16, v58
    s_add_u32 s57, s64, s70
    v_add_u32 v59, s66, v64
    ds_read_b128 v[60:63], v58
    s_waitcnt vmcnt(4)
    buffer_load_dwordx4 v[192:195], v2, s[32:35], s57 offen offset:0 nt
    buffer_load_dwordx4 v[196:199], v2, s[32:35], s57 offen offset:1024 nt
    buffer_load_dwordx4 v[200:203], v2, s[32:35], s57 offen offset:2048 nt
    buffer_load_dwordx4 v[204:207], v2, s[32:35], s57 offen offset:3072 nt
    s_add_u32 s57, s57, 4096
    s_cmp_lg_u32 s68, s69
    s_cbranch_scc1 L_flush1
L_fback1:
    v_lshrrev_b32 v56, 16, v48
    v_dot2c_f32_bf16 v33, v160, v48
    v_dot2c_f32_bf16 v35, v161, v48
    v_dot2c_f32_bf16 v37, v162, v48
    v_dot2c_f32_bf16 v39, v163, v48
    v_dot2c_f32_bf16 v32, v160, v56
    v_dot2c_f32_bf16 v34, v161, v56
    v_dot2c_f32_bf16 v36, v162, v56
    v_dot2c_f32_bf16 v38, v163, v56
    v_lshrrev_b32 v57, 16, v49
    v_dot2c_f32_bf16 v33, v164, v49
    v_dot2c_f32_bf16 v35, v165, v49
    v_dot2c_f32_bf16 v37, v166, v49
    v_dot2c_f32_bf16 v39, v167, v49
    v_dot2c_f32_bf16 v32, v164, v57
    v_dot2c_f32_bf16 v34, v165, v57
    v_dot2c_f32_bf16 v36, v166, v57
    v_dot2c_f32_bf16 v38, v167, v57
    v_lshrrev_b32 v56, 16, v50
    v_dot2c_f32_bf16 v33, v168, v50
    v_dot2c_f32_bf16 v35, v169, v50
    v_dot2c_f32_bf16 v37, v170, v50
    v_dot2c_f32_bf16 v39, v171, v50
    v_dot2c_f32_bf16 v32, v168, v56
    v_dot2c_f32_bf16 v34, v169, v56
    v_dot2c_f32_bf16 v36, v170, v56
    v_dot2c_f32_bf16 v38, v171, v56
    v_lshrrev_b32 v57, 16, v51
    v_dot2c_f32_bf16 v33, v172, v51
    v_dot2c_f32_bf16 v35, v173, v51
    v_dot2c_f32_bf16 v37, v174, v51
    v_dot2c_f32_bf16 v39, v175, v51
    v_dot2c_f32_bf16 v32, v172, v57
    v_dot2c_f32_bf16 v34, v173, v57
    v_dot2c_f32_bf16 v36, v174, v57
    v_dot2c_f32_bf16 v38, v175, v57
    ds_read_b128 v[40:43], v59
    ds_read_b128 v[44:47], v59 offset:16
    s_waitcnt vmcnt(4)
    buffer_load_dwordx4 v[208:211], v2, s[32:35], s57 offen offset:0 nt
    buffer_load_dwordx4 v[212:215], v2, s[32:35], s57 offen offset:1024 nt
    buffer_load_dwordx4 v[216:219], v2, s[32:35], s57 offen offset:2048 nt
    buffer_load_dwordx4 v[220:223], v2, s[32:35], s57 offen offset:3072 nt
    v_lshrrev_b32 v56, 16, v52
    v_dot2c_f32_bf16 v33, v176, v52
    v_dot2c_f32_bf16 v35, v177, v52
    v_dot2c_f32_bf16 v37, v178, v52
    v_dot2c_f32_bf16 v39, v179, v52
    v_dot2c_f32_bf16 v32, v176, v56
    v_dot2c_f32_bf16 v34, v177, v56
    v_dot2c_f32_bf16 v36, v178, v56
    v_dot2c_f32_bf16 v38, v179, v56
    v_lshrrev_b32 v57, 16, v53
    v_dot2c_f32_bf16 v33, v180, v53
    v_dot2c_f32_bf16 v35, v181, v53
    v_dot2c_f32_bf16 v37, v182, v53
    v_dot2c_f32_bf16 v39, v183, v53
    v_dot2c_f32_bf16 v32, v180, v57
    v_dot2c_f32_bf16 v34, v181, v57
    v_dot2c_f32_bf16 v36, v182, v57
    v_dot2c_f32_bf16 v38, v183, v57
    v_lshrrev_b32 v56, 16, v54
    v_dot2c_f32_bf16 v33, v184, v54
    v_dot2c_f32_bf16 v35, v185, v54
    v_dot2c_f32_bf16 v37, v186, v54
    v_dot2c_f32_bf16 v39, v187, v54
    v_dot2c_f32_bf16 v32, v184, v56
    v_dot2c_f32_bf16 v34, v185, v56
    v_dot2c_f32_bf16 v36, v186, v56
    v_dot2c_f32_bf16 v38, v187, v56
    v_lshrrev_b32 v57, 16, v55
    v_dot2c_f32_bf16 v33, v188, v55
    v_dot2c_f32_bf16 v35, v189, v55
    v_dot2c_f32_bf16 v37, v190, v55
    v_dot2c_f32_bf16 v39, v191, v55
    v_dot2c_f32_bf16 v32, v188, v57
    v_dot2c_f32_bf16 v34, v189, v57
    v_dot2c_f32_bf16 v36, v190, v57
    v_dot2c_f32_bf16 v38, v191, v57
    s_mov_b32 s68, s67
L_row2:
    s_waitcnt lgkmcnt(0)
    v_readfirstlane_b32 s64, v60
    v_readfirstlane_b32 s66, v61
    v_readfirstlane_b32 s67, v62
    s_cmp_ge_u32 s64, -2
    s_cbranch_scc1 L_odd2
    v_add_u32 v58, 16, v58
    s_add_u32 s57, s64, s70
    v_add_u32 v59, s66, v64
    ds_read_b128 v[60:63], v58
    s_waitcnt vmcnt(4)
    buffer_load_dwordx4 v[224:227], v2, s[32:35], s57 offen offset:0 nt
    buffer_load_dwordx4 v[228:231], v2, s[32:35], s57 offen offset:1024 nt
    buffer_load_dwordx4 v[232:235], v2, s[32:35], s57 offen offset:2048 nt
    buffer_load_dwordx4 v[236:239], v2, s[32:35], s57 offen offset:3072 nt
    s_add_u32 s57, s57, 4096
    s_cmp_lg_u32 s68, s69
    s_cbranch_scc1 L_flush2
L_fback2:
    v_lshrrev_b32 v56, 16, v40
    v_dot2c_f32_bf16 v33, v192, v40
    v_dot2c_f32_bf16 v35, v193, v40
    v_dot2c_f32_bf16 v37, v194, v40
    v_dot2c_f32_bf16 v39, v195, v40
    v_dot2c_f32_bf16 v32, v192, v56
    v_dot2c_f32_bf16 v34, v193, v56
    v_dot2c_f32_bf16 v36, v194, v56
    v_dot2c_f32_bf16 v38, v195, v56
    v_lshrrev_b32 v57, 16, v41
    v_dot2c_f32_bf16 v33, v196, v41
    v_dot2c_f32_bf16 v35, v197, v41
    v_dot2c_f32_bf16 v37, v198, v41
    v_dot2c_f32_bf16 v39, v199, v41
    v_dot2c_f32_bf16 v32, v196, v57
    v_dot2c_f32_bf16 v34, v197, v57
    v_dot2c_f32_bf16 v36, v198, v57
    v_dot2c_f32_bf16 v38, v199, v57
    v_lshrrev_b32 v56, 16, v42
    v_dot2c_f32_bf16 v33, v200, v42
    v_dot2c_f32_bf16 v35, v201, v42
    v_dot2c_f32_bf16 v37, v202, v42
    v_dot2c_f32_bf16 v39, v203, v42
    v_dot2c_f32_bf16 v32, v200, v56
    v_dot2c_f32_bf16 v34, v201, v56
    v_dot2c_f32_bf16 v36, v202, v56
    v_dot2c_f32_bf16 v38, v203, v56
    v_lshrrev_b32 v57, 16, v43
    v_dot2c_f32_bf16 v33, v204, v43
    v_dot2c_f32_bf16 v35, v205, v43
    v_dot2c_f32_bf16 v37, v206, v43
    v_dot2c_f32_bf16 v39, v207, v43
    v_dot2c_f32_bf16 v32, v204, v57
    v_dot2c_f32_bf16 v34, v205, v57
    v_dot2c_f32_bf16 v36, v206, v57
    v_dot2c_f32_bf16 v38, v207, v57
    ds_read_b128 v[48:51], v59
    ds_read_b128 v[52:55], v59 offset:16
    s_waitcnt vmcnt(4)
    buffer_load_dwordx4 v[240:243], v2, s[32:35], s57 offen offset:0 nt
    buffer_load_dwordx4 v[244:247], v2, s[32:35], s57 offen offset:1024 nt
    buffer_load_dwordx4 v[248:251], v2, s[32:35], s57 offen offset:2048 nt
    buffer_load_dwordx4 v[252:255], v2, s[32:35], s57 offen offset:3072 nt
    v_lshrrev_b32 v56, 16, v44
    v_dot2c_f32_bf16 v33, v208, v44
    v_dot2c_f32_bf16 v35, v209, v44
    v_dot2c_f32_bf16 v37, v210, v44
    v_dot2c_f32_bf16 v39, v211, v44
    v_dot2c_f32_bf16 v32, v208, v56
    v_dot2c_f32_bf16 v34, v209, v56
    v_dot2c_f32_bf16 v36, v210, v56
    v_dot2c_f32_bf16 v38, v211, v56
    v_lshrrev_b32 v57, 16, v45
    v_dot2c_f32_bf16 v33, v212, v45
    v_dot2c_f32_bf16 v35, v213, v45
    v_dot2c_f32_bf16 v37, v214, v45
    v_dot2c_f32_bf16 v39, v215, v45
    v_dot2c_f32_bf16 v32, v212, v57
    v_dot2c_f32_bf16 v34, v213, v57
    v_dot2c_f32_bf16 v36, v214, v57
    v_dot2c_f32_bf16 v38, v215, v57
    v_lshrrev_b32 v56, 16, v46
    v_dot2c_f32_bf16 v33, v216, v46
    v_dot2c_f32_bf16 v35, v217, v46
    v_dot2c_f32_bf16 v37, v218, v46
    v_dot2c_f32_bf16 v39, v219, v46
    v_dot2c_f32_bf16 v32, v216, v56
    v_dot2c_f32_bf16 v34, v217, v56
    v_dot2c_f32_bf16 v36, v218, v56
    v_dot2c_f32_bf16 v38, v219, v56
    v_lshrrev_b32 v57, 16, v47
    v_dot2c_f32_bf16 v33, v220, v47
    v_dot2c_f32_bf16 v35, v221, v47
    v_dot2c_f32_bf16 v37, v222, v47
    v_dot2c_f32_bf16 v39, v223, v47
    v_dot2c_f32_bf16 v32, v220, v57
    v_dot2c_f32_bf16 v34, v221, v57
    v_dot2c_f32_bf16 v36, v222, v57
    v_dot2c_f32_bf16 v38, v223, v57
    s_mov_b32 s68, s67
L_row3:
    s_waitcnt lgkmcnt(0)
    v_readfirstlane_b32 s64, v60
    v_readfirstlane_b32 s66, v61
    v_readfirstlane_b32 s67, v62
    s_cmp_ge_u32 s64, -2
    s_cbranch_scc1 L_odd3
    v_add_u32 v58, 16, v58
    s_add_u32 s57, s64, s70
    v_add_u32 v59, s66, v64
    ds_read_b128 v[60:63], v58
    s_waitcnt vmcnt(4)
    buffer_load_dwordx4 v[128:131], v2, s[32:35], s57 offen offset:0 nt
    buffer_load_dwordx4 v[132:135], v2, s[32:35], s57 offen offset:1024 nt
    buffer_load_dwordx4 v[136:139], v2, s[32:35], s57 offen offset:2048 nt
    buffer_load_dwordx4 v[140:143], v2, s[32:35], s57 offen offset:3072 nt
    s_add_u32 s57, s57, 4096
    s_cmp_lg_u32 s68, s69
    s_cbranch_scc1 L_flush3
L_fback3:
    v_lshrrev_b32 v56, 16, v48
    v_dot2c_f32_bf16 v33, v224, v48
    v_dot2c_f32_bf16 v35, v225, v48
    v_dot2c_f32_bf16 v37, v226, v48
    v_dot2c_f32_bf16 v39, v227, v48
    v_dot2c_f32_bf16 v32, v224, v56
    v_dot2c_f32_bf16 v34, v225, v56
    v_dot2c_f32_bf16 v36, v226, v56
    v_dot2c_f32_bf16 v38, v227, v56
    v_lshrrev_b32 v57, 16, v49
    v_dot2c_f32_bf16 v33, v228, v49
    v_dot2c_f32_bf16 v35, v229, v49
    v_dot2c_f32_bf16 v37, v230, v49
    v_dot2c_f32_bf16 v39, v231, v49
    v_dot2c_f32_bf16 v32, v228, v57
    v_dot2c_f32_bf16 v34, v229, v57
    v_dot2c_f32_bf16 v36, v230, v57
    v_dot2c_f32_bf16 v38, v231, v57
    v_lshrrev_b32 v56, 16, v50
    v_dot2c_f32_bf16 v33, v232, v50
    v_dot2c_f32_bf16 v35, v233, v50
    v_dot2c_f32_bf16 v37, v234, v50
    v_dot2c_f32_bf16 v39, v235, v50
    v_dot2c_f32_bf16 v32, v232, v56
    v_dot2c_f32_bf16 v34, v233, v56
    v_dot2c_f32_bf16 v36, v234, v56
    v_dot2c_f32_bf16 v38, v235, v56
    v_lshrrev_b32 v57, 16, v51
    v_dot2c_f32_bf16 v33, v236, v51
    v_dot2c_f32_bf16 v35, v237, v51
    v_dot2c_f32_bf16 v37, v238, v51
    v_dot2c_f32_bf16 v39, v239, v51
    v_dot2c_f32_bf16 v32, v236, v57
    v_dot2c_f32_bf16 v34, v237, v57
    v_dot2c_f32_bf16 v36, v238, v57
    v_dot2c_f32_bf16 v38, v239, v57
    ds_read_b128 v[40:43], v59
    ds_read_b128 v[44:47], v59 offset:16
    s_waitcnt vmcnt(4)
    buffer_load_dwordx4 v[144:147], v2, s[32:35], s57 offen offset:0 nt
    buffer_load_dwordx4 v[148:151], v2, s[32:35], s57 offen offset:1024 nt
    buffer_load_dwordx4 v[152:155], v2, s[32:35], s57 offen offset:2048 nt
    buffer_load_dwordx4 v[156:159], v2, s[32:35], s57 offen offset:3072 nt
    v_lshrrev_b32 v56, 16, v52
    v_dot2c_f32_bf16 v33, v240, v52
    v_dot2c_f32_bf16 v35, v241, v52
    v_dot2c_f32_bf16 v37, v242, v52
    v_dot2c_f32_bf16 v39, v243, v52
    v_dot2c_f32_bf16 v32, v240, v56
    v_dot2c_f32_bf16 v34, v241, v56
    v_dot2c_f32_bf16 v36, v242, v56
    v_dot2c_f32_bf16 v38, v243, v56
    v_lshrrev_b32 v57, 16, v53
    v_dot2c_f32_bf16 v33, v244, v53
    v_dot2c_f32_bf16 v35, v245, v53
    v_dot2c_f32_bf16 v37, v246, v53
    v_dot2c_f32_bf16 v39, v247, v53
    v_dot2c_f32_bf16 v32, v244, v57
    v_dot2c_f32_bf16 v34, v245, v57
    v_dot2c_f32_bf16 v36, v246, v57
    v_dot2c_f32_bf16 v38, v247, v57
    v_lshrrev_b32 v56, 16, v54
    v_dot2c_f32_bf16 v33, v248, v54
    v_dot2c_f32_bf16 v35, v249, v54
    v_dot2c_f32_bf16 v37, v250, v54
    v_dot2c_f32_bf16 v39, v251, v54
    v_dot2c_f32_bf16 v32, v248, v56
    v_dot2c_f32_bf16 v34, v249, v56
    v_dot2c_f32_bf16 v36, v250, v56
    v_dot2c_f32_bf16 v38, v251, v56
    v_lshrrev_b32 v57, 16, v55
    v_dot2c_f32_bf16 v33, v252, v55
    v_dot2c_f32_bf16 v35, v253, v55
    v_dot2c_f32_bf16 v37, v254, v55
    v_dot2c_f32_bf16 v39, v255, v55
    v_dot2c_f32_bf16 v32, v252, v57
    v_dot2c_f32_bf16 v34, v253, v57
    v_dot2c_f32_bf16 v36, v254, v57
    v_dot2c_f32_bf16 v38, v255, v57
    s_mov_b32 s68, s67
    s_branch L_row0
L_flush0:
    s_nop 4
    s_bitcmp1_b32 s68, 9
    s_cbranch_scc0 L_nodeca0
    v_mov_b32 v19, 1
    v_mov_b32 v20, 0
    ds_write_b32 v20, v19 offset:24724
    s_and_b32 s68, s68, 7
    s_branch L_fzxa0
L_nodeca0:
    v_permlane16_swap_b32 v32, v33
    v_permlane16_swap_b32 v34, v35
    v_permlane16_swap_b32 v36, v37
    v_permlane16_swap_b32 v38, v39
    v_add_f32 v32, v32, v33
    v_add_f32 v34, v34, v35
    v_add_f32 v36, v36, v37
    v_add_f32 v38, v38, v39
    v_permlane32_swap_b32 v32, v34
    s_nop 0
    v_permlane32_swap_b32 v36, v38
    v_add_f32 v32, v32, v34
    v_add_f32 v36, v36, v38
    s_lshl_b32 s52, s69, 9
    v_add_u32 v18, s52, v31
    ds_add_f32 v18, v32 offset:20480
    ds_add_f32 v18, v36 offset:20496
    v_mov_b32 v32, 0
    v_mov_b32 v33, 0
    v_mov_b32 v34, 0
    v_mov_b32 v35, 0
    v_mov_b32 v36, 0
    v_mov_b32 v37, 0
    v_mov_b32 v38, 0
    v_mov_b32 v39, 0
    s_bitcmp1_b32 s68, 8
    s_cbranch_scc0 L_nosiga0
    v_mov_b32 v19, 1
    v_mov_b32 v20, 0
    s_mov_b64 exec, 1
    ds_add_u32 v20, v19 offset:24708
    s_mov_b64 exec, -1
L_nosiga0:
    s_and_b32 s68, s68, 7
    s_mov_b32 s69, s68
L_fzxa0:
    s_branch L_fback0
L_odd0:
    s_cmp_eq_u32 s64, -1
    s_cbranch_scc1 L_last0
    s_mov_b32 s65, 0
L_pend0:
    ds_read_b128 v[60:63], v58
    s_waitcnt lgkmcnt(0)
    v_readfirstlane_b32 s64, v60
    s_add_u32 s65, s65, 1
    s_cmp_gt_u32 s65, 1600000
    s_cbranch_scc1 L_last0
    s_cmp_eq_u32 s64, -2
    s_cbranch_scc1 L_pend0
    s_branch L_row0
L_last0:
    s_cmp_eq_u32 s68, s69
    s_cbranch_scc1 L_last20
    s_bitcmp1_b32 s68, 9
    s_cbranch_scc0 L_nodecb0
    v_mov_b32 v19, 1
    v_mov_b32 v20, 0
    ds_write_b32 v20, v19 offset:24724
    s_and_b32 s68, s68, 7
    s_branch L_fzxb0
L_nodecb0:
    v_permlane16_swap_b32 v32, v33
    v_permlane16_swap_b32 v34, v35
    v_permlane16_swap_b32 v36, v37
    v_permlane16_swap_b32 v38, v39
    v_add_f32 v32, v32, v33
    v_add_f32 v34, v34, v35
    v_add_f32 v36, v36, v37
    v_add_f32 v38, v38, v39
    v_permlane32_swap_b32 v32, v34
    s_nop 0
    v_permlane32_swap_b32 v36, v38
    v_add_f32 v32, v32, v34
    v_add_f32 v36, v36, v38
    s_lshl_b32 s52, s69, 9
    v_add_u32 v18, s52, v31
    ds_add_f32 v18, v32 offset:20480
    ds_add_f32 v18, v36 offset:20496
    v_mov_b32 v32, 0
    v_mov_b32 v33, 0
    v_mov_b32 v34, 0
    v_mov_b32 v35, 0
    v_mov_b32 v36, 0
    v_mov_b32 v37, 0
    v_mov_b32 v38, 0
    v_mov_b32 v39, 0
    s_bitcmp1_b32 s68, 8
    s_cbranch_scc0 L_nosigb0
    v_mov_b32 v19, 1
    v_mov_b32 v20, 0
    s_mov_b64 exec, 1
    ds_add_u32 v20, v19 offset:24708
    s_mov_b64 exec, -1
L_nosigb0:
    s_and_b32 s68, s68, 7
    s_mov_b32 s69, s68
L_fzxb0:
L_last20:
    s_waitcnt vmcnt(4)
    v_lshrrev_b32 v56, 16, v40
    v_dot2c_f32_bf16 v33, v128, v40
    v_dot2c_f32_bf16 v35, v129, v40
    v_dot2c_f32_bf16 v37, v130, v40
    v_dot2c_f32_bf16 v39, v131, v40
    v_dot2c_f32_bf16 v32, v128, v56
    v_dot2c_f32_bf16 v34, v129, v56
    v_dot2c_f32_bf16 v36, v130, v56
    v_dot2c_f32_bf16 v38, v131, v56
    v_lshrrev_b32 v57, 16, v41
    v_dot2c_f32_bf16 v33, v132, v41
    v_dot2c_f32_bf16 v35, v133, v41
    v_dot2c_f32_bf16 v37, v134, v41
    v_dot2c_f32_bf16 v39, v135, v41
    v_dot2c_f32_bf16 v32, v132, v57
    v_dot2c_f32_bf16 v34, v133, v57
    v_dot2c_f32_bf16 v36, v134, v57
    v_dot2c_f32_bf16 v38, v135, v57
    v_lshrrev_b32 v56, 16, v42
    v_dot2c_f32_bf16 v33, v136, v42
    v_dot2c_f32_bf16 v35, v137, v42
    v_dot2c_f32_bf16 v37, v138, v42
    v_dot2c_f32_bf16 v39, v139, v42
    v_dot2c_f32_bf16 v32, v136, v56
    v_dot2c_f32_bf16 v34, v137, v56
    v_dot2c_f32_bf16 v36, v138, v56
    v_dot2c_f32_bf16 v38, v139, v56
    v_lshrrev_b32 v57, 16, v43
    v_dot2c_f32_bf16 v33, v140, v43
    v_dot2c_f32_bf16 v35, v141, v43
    v_dot2c_f32_bf16 v37, v142, v43
    v_dot2c_f32_bf16 v39, v143, v43
    v_dot2c_f32_bf16 v32, v140, v57
    v_dot2c_f32_bf16 v34, v141, v57
    v_dot2c_f32_bf16 v36, v142, v57
    v_dot2c_f32_bf16 v38, v143, v57
    s_waitcnt vmcnt(0)
    v_lshrrev_b32 v56, 16, v44
    v_dot2c_f32_bf16 v33, v144, v44
    v_dot2c_f32_bf16 v35, v145, v44
    v_dot2c_f32_bf16 v37, v146, v44
    v_dot2c_f32_bf16 v39, v147, v44
    v_dot2c_f32_bf16 v32, v144, v56
    v_dot2c_f32_bf16 v34, v145, v56
    v_dot2c_f32_bf16 v36, v146, v56
    v_dot2c_f32_bf16 v38, v147, v56
    v_lshrrev_b32 v57, 16, v45
    v_dot2c_f32_bf16 v33, v148, v45
    v_dot2c_f32_bf16 v35, v149, v45
    v_dot2c_f32_bf16 v37, v150, v45
    v_dot2c_f32_bf16 v39, v151, v45
    v_dot2c_f32_bf16 v32, v148, v57
    v_dot2c_f32_bf16 v34, v149, v57
    v_dot2c_f32_bf16 v36, v150, v57
    v_dot2c_f32_bf16 v38, v151, v57
    v_lshrrev_b32 v56, 16, v46
    v_dot2c_f32_bf16 v33, v152, v46
    v_dot2c_f32_bf16 v35, v153, v46
    v_dot2c_f32_bf16 v37, v154, v46
    v_dot2c_f32_bf16 v39, v155, v46
    v_dot2c_f32_bf16 v32, v152, v56
    v_dot2c_f32_bf16 v34, v153, v56
    v_dot2c_f32_bf16 v36, v154, v56
    v_dot2c_f32_bf16 v38, v155, v56
    v_lshrrev_b32 v57, 16, v47
    v_dot2c_f32_bf16 v33, v156, v47
    v_dot2c_f32_bf16 v35, v157, v47
    v_dot2c_f32_bf16 v37, v158, v47
    v_dot2c_f32_bf16 v39, v159, v47
    v_dot2c_f32_bf16 v32, v156, v57
    v_dot2c_f32_bf16 v34, v157, v57
    v_dot2c_f32_bf16 v36, v158, v57
    v_dot2c_f32_bf16 v38, v159, v57
    s_branch L_vdone
L_flush1:
    s_nop 4
    s_bitcmp1_b32 s68, 9
    s_cbranch_scc0 L_nodeca1
    v_mov_b32 v19, 1
    v_mov_b32 v20, 0
    ds_write_b32 v20, v19 offset:24724
    s_and_b32 s68, s68, 7
    s_branch L_fzxa1
L_nodeca1:
    v_permlane16_swap_b32 v32, v33
    v_permlane16_swap_b32 v34, v35
    v_permlane16_swap_b32 v36, v37
    v_permlane16_swap_b32 v38, v39
    v_add_f32 v32, v32, v33
    v_add_f32 v34, v34, v35
    v_add_f32 v36, v36, v37
    v_add_f32 v38, v38, v39
    v_permlane32_swap_b32 v32, v34
    s_nop 0
    v_permlane32_swap_b32 v36, v38
    v_add_f32 v32, v32, v34
    v_add_f32 v36, v36, v38
    s_lshl_b32 s52, s69, 9
    v_add_u32 v18, s52, v31
    ds_add_f32 v18, v32 offset:20480
    ds_add_f32 v18, v36 offset:20496
    v_mov_b32 v32, 0
    v_mov_b32 v33, 0
    v_mov_b32 v34, 0
    v_mov_b32 v35, 0
    v_mov_b32 v36, 0
    v_mov_b32 v37, 0
    v_mov_b32 v38, 0
    v_mov_b32 v39, 0
    s_bitcmp1_b32 s68, 8
    s_cbranch_scc0 L_nosiga1
    v_mov_b32 v19, 1
    v_mov_b32 v20, 0
    s_mov_b64 exec, 1
    ds_add_u32 v20, v19 offset:24708
    s_mov_b64 exec, -1
L_nosiga1:
    s_and_b32 s68, s68, 7
    s_mov_b32 s69, s68
L_fzxa1:
    s_branch L_fback1
L_odd1:
    s_cmp_eq_u32 s64, -1
    s_cbranch_scc1 L_last1
    s_mov_b32 s65, 0
L_pend1:
    ds_read_b128 v[60:63], v58
    s_waitcnt lgkmcnt(0)
    v_readfirstlane_b32 s64, v60
    s_add_u32 s65, s65, 1
    s_cmp_gt_u32 s65, 1600000
    s_cbranch_scc1 L_last1
    s_cmp_eq_u32 s64, -2
    s_cbranch_scc1 L_pend1
    s_branch L_row1
L_last1:
    s_cmp_eq_u32 s68, s69
    s_cbranch_scc1 L_last21
    s_bitcmp1_b32 s68, 9
    s_cbranch_scc0 L_nodecb1
    v_mov_b32 v19, 1
    v_mov_b32 v20, 0
    ds_write_b32 v20, v19 offset:24724
    s_and_b32 s68, s68, 7
    s_branch L_fzxb1
L_nodecb1:
    v_permlane16_swap_b32 v32, v33
    v_permlane16_swap_b32 v34, v35
    v_permlane16_swap_b32 v36, v37
    v_permlane16_swap_b32 v38, v39
    v_add_f32 v32, v32, v33
    v_add_f32 v34, v34, v35
    v_add_f32 v36, v36, v37
    v_add_f32 v38, v38, v39
    v_permlane32_swap_b32 v32, v34
    s_nop 0
    v_permlane32_swap_b32 v36, v38
    v_add_f32 v32, v32, v34
    v_add_f32 v36, v36, v38
    s_lshl_b32 s52, s69, 9
    v_add_u32 v18, s52, v31
    ds_add_f32 v18, v32 offset:20480
    ds_add_f32 v18, v36 offset:20496
    v_mov_b32 v32, 0
    v_mov_b32 v33, 0
    v_mov_b32 v34, 0
    v_mov_b32 v35, 0
    v_mov_b32 v36, 0
    v_mov_b32 v37, 0
    v_mov_b32 v38, 0
    v_mov_b32 v39, 0
    s_bitcmp1_b32 s68, 8
    s_cbranch_scc0 L_nosigb1
    v_mov_b32 v19, 1
    v_mov_b32 v20, 0
    s_mov_b64 exec, 1
    ds_add_u32 v20, v19 offset:24708
    s_mov_b64 exec, -1
L_nosigb1:
    s_and_b32 s68, s68, 7
    s_mov_b32 s69, s68
L_fzxb1:
L_last21:
    s_waitcnt vmcnt(4)
    v_lshrrev_b32 v56, 16, v48
    v_dot2c_f32_bf16 v33, v160, v48
    v_dot2c_f32_bf16 v35, v161, v48
    v_dot2c_f32_bf16 v37, v162, v48
    v_dot2c_f32_bf16 v39, v163, v48
    v_dot2c_f32_bf16 v32, v160, v56
    v_dot2c_f32_bf16 v34, v161, v56
    v_dot2c_f32_bf16 v36, v162, v56
    v_dot2c_f32_bf16 v38, v163, v56
    v_lshrrev_b32 v57, 16, v49
    v_dot2c_f32_bf16 v33, v164, v49
    v_dot2c_f32_bf16 v35, v165, v49
    v_dot2c_f32_bf16 v37, v166, v49
    v_dot2c_f32_bf16 v39, v167, v49
    v_dot2c_f32_bf16 v32, v164, v57
    v_dot2c_f32_bf16 v34, v165, v57
    v_dot2c_f32_bf16 v36, v166, v57
    v_dot2c_f32_bf16 v38, v167, v57
    v_lshrrev_b32 v56, 16, v50
    v_dot2c_f32_bf16 v33, v168, v50
    v_dot2c_f32_bf16 v35, v169, v50
    v_dot2c_f32_bf16 v37, v170, v50
    v_dot2c_f32_bf16 v39, v171, v50
    v_dot2c_f32_bf16 v32, v168, v56
    v_dot2c_f32_bf16 v34, v169, v56
    v_dot2c_f32_bf16 v36, v170, v56
    v_dot2c_f32_bf16 v38, v171, v56
    v_lshrrev_b32 v57, 16, v51
    v_dot2c_f32_bf16 v33, v172, v51
    v_dot2c_f32_bf16 v35, v173, v51
    v_dot2c_f32_bf16 v37, v174, v51
    v_dot2c_f32_bf16 v39, v175, v51
    v_dot2c_f32_bf16 v32, v172, v57
    v_dot2c_f32_bf16 v34, v173, v57
    v_dot2c_f32_bf16 v36, v174, v57
    v_dot2c_f32_bf16 v38, v175, v57
    s_waitcnt vmcnt(0)
    v_lshrrev_b32 v56, 16, v52
    v_dot2c_f32_bf16 v33, v176, v52
    v_dot2c_f32_bf16 v35, v177, v52
    v_dot2c_f32_bf16 v37, v178, v52
    v_dot2c_f32_bf16 v39, v179, v52
    v_dot2c_f32_bf16 v32, v176, v56
    v_dot2c_f32_bf16 v34, v177, v56
    v_dot2c_f32_bf16 v36, v178, v56
    v_dot2c_f32_bf16 v38, v179, v56
    v_lshrrev_b32 v57, 16, v53
    v_dot2c_f32_bf16 v33, v180, v53
    v_dot2c_f32_bf16 v35, v181, v53
    v_dot2c_f32_bf16 v37, v182, v53
    v_dot2c_f32_bf16 v39, v183, v53
    v_dot2c_f32_bf16 v32, v180, v57
    v_dot2c_f32_bf16 v34, v181, v57
    v_dot2c_f32_bf16 v36, v182, v57
    v_dot2c_f32_bf16 v38, v183, v57
    v_lshrrev_b32 v56, 16, v54
    v_dot2c_f32_bf16 v33, v184, v54
    v_dot2c_f32_bf16 v35, v185, v54
    v_dot2c_f32_bf16 v37, v186, v54
    v_dot2c_f32_bf16 v39, v187, v54
    v_dot2c_f32_bf16 v32, v184, v56
    v_dot2c_f32_bf16 v34, v185, v56
    v_dot2c_f32_bf16 v36, v186, v56
    v_dot2c_f32_bf16 v38, v187, v56
    v_lshrrev_b32 v57, 16, v55
    v_dot2c_f32_bf16 v33, v188, v55
    v_dot2c_f32_bf16 v35, v189, v55
    v_dot2c_f32_bf16 v37, v190, v55
    v_dot2c_f32_bf16 v39, v191, v55
    v_dot2c_f32_bf16 v32, v188, v57
    v_dot2c_f32_bf16 v34, v189, v57
    v_dot2c_f32_bf16 v36, v190, v57
    v_dot2c_f32_bf16 v38, v191, v57
    s_branch L_vdone
L_flush2:
    s_nop 4
    s_bitcmp1_b32 s68, 9
    s_cbranch_scc0 L_nodeca2
    v_mov_b32 v19, 1
    v_mov_b32 v20, 0
    ds_write_b32 v20, v19 offset:24724
    s_and_b32 s68, s68, 7
    s_branch L_fzxa2
L_nodeca2:
    v_permlane16_swap_b32 v32, v33
    v_permlane16_swap_b32 v34, v35
    v_permlane16_swap_b32 v36, v37
    v_permlane16_swap_b32 v38, v39
    v_add_f32 v32, v32, v33
    v_add_f32 v34, v34, v35
    v_add_f32 v36, v36, v37
    v_add_f32 v38, v38, v39
    v_permlane32_swap_b32 v32, v34
    s_nop 0
    v_permlane32_swap_b32 v36, v38
    v_add_f32 v32, v32, v34
    v_add_f32 v36, v36, v38
    s_lshl_b32 s52, s69, 9
    v_add_u32 v18, s52, v31
    ds_add_f32 v18, v32 offset:20480
    ds_add_f32 v18, v36 offset:20496
    v_mov_b32 v32, 0
    v_mov_b32 v33, 0
    v_mov_b32 v34, 0
    v_mov_b32 v35, 0
    v_mov_b32 v36, 0
    v_mov_b32 v37, 0
    v_mov_b32 v38, 0
    v_mov_b32 v39, 0
    s_bitcmp1_b32 s68, 8
    s_cbranch_scc0 L_nosiga2
    v_mov_b32 v19, 1
    v_mov_b32 v20, 0
    s_mov_b64 exec, 1
    ds_add_u32 v20, v19 offset:24708
    s_mov_b64 exec, -1
L_nosiga2:
    s_and_b32 s68, s68, 7
    s_mov_b32 s69, s68
L_fzxa2:
    s_branch L_fback2
L_odd2:
    s_cmp_eq_u32 s64, -1
    s_cbranch_scc1 L_last2
    s_mov_b32 s65, 0
L_pend2:
    ds_read_b128 v[60:63], v58
    s_waitcnt lgkmcnt(0)
    v_readfirstlane_b32 s64, v60
    s_add_u32 s65, s65, 1
    s_cmp_gt_u32 s65, 1600000
    s_cbranch_scc1 L_last2
    s_cmp_eq_u32 s64, -2
    s_cbranch_scc1 L_pend2
    s_branch L_row2
L_last2:
    s_cmp_eq_u32 s68, s69
    s_cbranch_scc1 L_last22
    s_bitcmp1_b32 s68, 9
    s_cbranch_scc0 L_nodecb2
    v_mov_b32 v19, 1
    v_mov_b32 v20, 0
    ds_write_b32 v20, v19 offset:24724
    s_and_b32 s68, s68, 7
    s_branch L_fzxb2
L_nodecb2:
    v_permlane16_swap_b32 v32, v33
    v_permlane16_swap_b32 v34, v35
    v_permlane16_swap_b32 v36, v37
    v_permlane16_swap_b32 v38, v39
    v_add_f32 v32, v32, v33
    v_add_f32 v34, v34, v35
    v_add_f32 v36, v36, v37
    v_add_f32 v38, v38, v39
    v_permlane32_swap_b32 v32, v34
    s_nop 0
    v_permlane32_swap_b32 v36, v38
    v_add_f32 v32, v32, v34
    v_add_f32 v36, v36, v38
    s_lshl_b32 s52, s69, 9
    v_add_u32 v18, s52, v31
    ds_add_f32 v18, v32 offset:20480
    ds_add_f32 v18, v36 offset:20496
    v_mov_b32 v32, 0
    v_mov_b32 v33, 0
    v_mov_b32 v34, 0
    v_mov_b32 v35, 0
    v_mov_b32 v36, 0
    v_mov_b32 v37, 0
    v_mov_b32 v38, 0
    v_mov_b32 v39, 0
    s_bitcmp1_b32 s68, 8
    s_cbranch_scc0 L_nosigb2
    v_mov_b32 v19, 1
    v_mov_b32 v20, 0
    s_mov_b64 exec, 1
    ds_add_u32 v20, v19 offset:24708
    s_mov_b64 exec, -1
L_nosigb2:
    s_and_b32 s68, s68, 7
    s_mov_b32 s69, s68
L_fzxb2:
L_last22:
    s_waitcnt vmcnt(4)
    v_lshrrev_b32 v56, 16, v40
    v_dot2c_f32_bf16 v33, v192, v40
    v_dot2c_f32_bf16 v35, v193, v40
    v_dot2c_f32_bf16 v37, v194, v40
    v_dot2c_f32_bf16 v39, v195, v40
    v_dot2c_f32_bf16 v32, v192, v56
    v_dot2c_f32_bf16 v34, v193, v56
    v_dot2c_f32_bf16 v36, v194, v56
    v_dot2c_f32_bf16 v38, v195, v56
    v_lshrrev_b32 v57, 16, v41
    v_dot2c_f32_bf16 v33, v196, v41
    v_dot2c_f32_bf16 v35, v197, v41
    v_dot2c_f32_bf16 v37, v198, v41
    v_dot2c_f32_bf16 v39, v199, v41
    v_dot2c_f32_bf16 v32, v196, v57
    v_dot2c_f32_bf16 v34, v197, v57
    v_dot2c_f32_bf16 v36, v198, v57
    v_dot2c_f32_bf16 v38, v199, v57
    v_lshrrev_b32 v56, 16, v42
    v_dot2c_f32_bf16 v33, v200, v42
    v_dot2c_f32_bf16 v35, v201, v42
    v_dot2c_f32_bf16 v37, v202, v42
    v_dot2c_f32_bf16 v39, v203, v42
    v_dot2c_f32_bf16 v32, v200, v56
    v_dot2c_f32_bf16 v34, v201, v56
    v_dot2c_f32_bf16 v36, v202, v56
    v_dot2c_f32_bf16 v38, v203, v56
    v_lshrrev_b32 v57, 16, v43
    v_dot2c_f32_bf16 v33, v204, v43
    v_dot2c_f32_bf16 v35, v205, v43
    v_dot2c_f32_bf16 v37, v206, v43
    v_dot2c_f32_bf16 v39, v207, v43
    v_dot2c_f32_bf16 v32, v204, v57
    v_dot2c_f32_bf16 v34, v205, v57
    v_dot2c_f32_bf16 v36, v206, v57
    v_dot2c_f32_bf16 v38, v207, v57
    s_waitcnt vmcnt(0)
    v_lshrrev_b32 v56, 16, v44
    v_dot2c_f32_bf16 v33, v208, v44
    v_dot2c_f32_bf16 v35, v209, v44
    v_dot2c_f32_bf16 v37, v210, v44
    v_dot2c_f32_bf16 v39, v211, v44
    v_dot2c_f32_bf16 v32, v208, v56
    v_dot2c_f32_bf16 v34, v209, v56
    v_dot2c_f32_bf16 v36, v210, v56
    v_dot2c_f32_bf16 v38, v211, v56
    v_lshrrev_b32 v57, 16, v45
    v_dot2c_f32_bf16 v33, v212, v45
    v_dot2c_f32_bf16 v35, v213, v45
    v_dot2c_f32_bf16 v37, v214, v45
    v_dot2c_f32_bf16 v39, v215, v45
    v_dot2c_f32_bf16 v32, v212, v57
    v_dot2c_f32_bf16 v34, v213, v57
    v_dot2c_f32_bf16 v36, v214, v57
    v_dot2c_f32_bf16 v38, v215, v57
    v_lshrrev_b32 v56, 16, v46
    v_dot2c_f32_bf16 v33, v216, v46
    v_dot2c_f32_bf16 v35, v217, v46
    v_dot2c_f32_bf16 v37, v218, v46
    v_dot2c_f32_bf16 v39, v219, v46
    v_dot2c_f32_bf16 v32, v216, v56
    v_dot2c_f32_bf16 v34, v217, v56
    v_dot2c_f32_bf16 v36, v218, v56
    v_dot2c_f32_bf16 v38, v219, v56
    v_lshrrev_b32 v57, 16, v47
    v_dot2c_f32_bf16 v33, v220, v47
    v_dot2c_f32_bf16 v35, v221, v47
    v_dot2c_f32_bf16 v37, v222, v47
    v_dot2c_f32_bf16 v39, v223, v47
    v_dot2c_f32_bf16 v32, v220, v57
    v_dot2c_f32_bf16 v34, v221, v57
    v_dot2c_f32_bf16 v36, v222, v57
    v_dot2c_f32_bf16 v38, v223, v57
    s_branch L_vdone
L_flush3:
    s_nop 4
    s_bitcmp1_b32 s68, 9
    s_cbranch_scc0 L_nodeca3
    v_mov_b32 v19, 1
    v_mov_b32 v20, 0
    ds_write_b32 v20, v19 offset:24724
    s_and_b32 s68, s68, 7
    s_branch L_fzxa3
L_nodeca3:
    v_permlane16_swap_b32 v32, v33
    v_permlane16_swap_b32 v34, v35
    v_permlane16_swap_b32 v36, v37
    v_permlane16_swap_b32 v38, v39
    v_add_f32 v32, v32, v33
    v_add_f32 v34, v34, v35
    v_add_f32 v36, v36, v37
    v_add_f32 v38, v38, v39
    v_permlane32_swap_b32 v32, v34
    s_nop 0
    v_permlane32_swap_b32 v36, v38
    v_add_f32 v32, v32, v34
    v_add_f32 v36, v36, v38
    s_lshl_b32 s52, s69, 9
    v_add_u32 v18, s52, v31
    ds_add_f32 v18, v32 offset:20480
    ds_add_f32 v18, v36 offset:20496
    v_mov_b32 v32, 0
    v_mov_b32 v33, 0
    v_mov_b32 v34, 0
    v_mov_b32 v35, 0
    v_mov_b32 v36, 0
    v_mov_b32 v37, 0
    v_mov_b32 v38, 0
    v_mov_b32 v39, 0
    s_bitcmp1_b32 s68, 8
    s_cbranch_scc0 L_nosiga3
    v_mov_b32 v19, 1
    v_mov_b32 v20, 0
    s_mov_b64 exec, 1
    ds_add_u32 v20, v19 offset:24708
    s_mov_b64 exec, -1
L_nosiga3:
    s_and_b32 s68, s68, 7
    s_mov_b32 s69, s68
L_fzxa3:
    s_branch L_fback3
L_odd3:
    s_cmp_eq_u32 s64, -1
    s_cbranch_scc1 L_last3
    s_mov_b32 s65, 0
L_pend3:
    ds_read_b128 v[60:63], v58
    s_waitcnt lgkmcnt(0)
    v_readfirstlane_b32 s64, v60
    s_add_u32 s65, s65, 1
    s_cmp_gt_u32 s65, 1600000
    s_cbranch_scc1 L_last3
    s_cmp_eq_u32 s64, -2
    s_cbranch_scc1 L_pend3
    s_branch L_row3
L_last3:
    s_cmp_eq_u32 s68, s69
    s_cbranch_scc1 L_last23
    s_bitcmp1_b32 s68, 9
    s_cbranch_scc0 L_nodecb3
    v_mov_b32 v19, 1
    v_mov_b32 v20, 0
    ds_write_b32 v20, v19 offset:24724
    s_and_b32 s68, s68, 7
    s_branch L_fzxb3
L_nodecb3:
    v_permlane16_swap_b32 v32, v33
    v_permlane16_swap_b32 v34, v35
    v_permlane16_swap_b32 v36, v37
    v_permlane16_swap_b32 v38, v39
    v_add_f32 v32, v32, v33
    v_add_f32 v34, v34, v35
    v_add_f32 v36, v36, v37
    v_add_f32 v38, v38, v39
    v_permlane32_swap_b32 v32, v34
    s_nop 0
    v_permlane32_swap_b32 v36, v38
    v_add_f32 v32, v32, v34
    v_add_f32 v36, v36, v38
    s_lshl_b32 s52, s69, 9
    v_add_u32 v18, s52, v31
    ds_add_f32 v18, v32 offset:20480
    ds_add_f32 v18, v36 offset:20496
    v_mov_b32 v32, 0
    v_mov_b32 v33, 0
    v_mov_b32 v34, 0
    v_mov_b32 v35, 0
    v_mov_b32 v36, 0
    v_mov_b32 v37, 0
    v_mov_b32 v38, 0
    v_mov_b32 v39, 0
    s_bitcmp1_b32 s68, 8
    s_cbranch_scc0 L_nosigb3
    v_mov_b32 v19, 1
    v_mov_b32 v20, 0
    s_mov_b64 exec, 1
    ds_add_u32 v20, v19 offset:24708
    s_mov_b64 exec, -1
L_nosigb3:
    s_and_b32 s68, s68, 7
    s_mov_b32 s69, s68
L_fzxb3:
L_last23:
    s_waitcnt vmcnt(4)
    v_lshrrev_b32 v56, 16, v48
    v_dot2c_f32_bf16 v33, v224, v48
    v_dot2c_f32_bf16 v35, v225, v48
    v_dot2c_f32_bf16 v37, v226, v48
    v_dot2c_f32_bf16 v39, v227, v48
    v_dot2c_f32_bf16 v32, v224, v56
    v_dot2c_f32_bf16 v34, v225, v56
    v_dot2c_f32_bf16 v36, v226, v56
    v_dot2c_f32_bf16 v38, v227, v56
    v_lshrrev_b32 v57, 16, v49
    v_dot2c_f32_bf16 v33, v228, v49
    v_dot2c_f32_bf16 v35, v229, v49
    v_dot2c_f32_bf16 v37, v230, v49
    v_dot2c_f32_bf16 v39, v231, v49
    v_dot2c_f32_bf16 v32, v228, v57
    v_dot2c_f32_bf16 v34, v229, v57
    v_dot2c_f32_bf16 v36, v230, v57
    v_dot2c_f32_bf16 v38, v231, v57
    v_lshrrev_b32 v56, 16, v50
    v_dot2c_f32_bf16 v33, v232, v50
    v_dot2c_f32_bf16 v35, v233, v50
    v_dot2c_f32_bf16 v37, v234, v50
    v_dot2c_f32_bf16 v39, v235, v50
    v_dot2c_f32_bf16 v32, v232, v56
    v_dot2c_f32_bf16 v34, v233, v56
    v_dot2c_f32_bf16 v36, v234, v56
    v_dot2c_f32_bf16 v38, v235, v56
    v_lshrrev_b32 v57, 16, v51
    v_dot2c_f32_bf16 v33, v236, v51
    v_dot2c_f32_bf16 v35, v237, v51
    v_dot2c_f32_bf16 v37, v238, v51
    v_dot2c_f32_bf16 v39, v239, v51
    v_dot2c_f32_bf16 v32, v236, v57
    v_dot2c_f32_bf16 v34, v237, v57
    v_dot2c_f32_bf16 v36, v238, v57
    v_dot2c_f32_bf16 v38, v239, v57
    s_waitcnt vmcnt(0)
    v_lshrrev_b32 v56, 16, v52
    v_dot2c_f32_bf16 v33, v240, v52
    v_dot2c_f32_bf16 v35, v241, v52
    v_dot2c_f32_bf16 v37, v242, v52
    v_dot2c_f32_bf16 v39, v243, v52
    v_dot2c_f32_bf16 v32, v240, v56
    v_dot2c_f32_bf16 v34, v241, v56
    v_dot2c_f32_bf16 v36, v242, v56
    v_dot2c_f32_bf16 v38, v243, v56
    v_lshrrev_b32 v57, 16, v53
    v_dot2c_f32_bf16 v33, v244, v53
    v_dot2c_f32_bf16 v35, v245, v53
    v_dot2c_f32_bf16 v37, v246, v53
    v_dot2c_f32_bf16 v39, v247, v53
    v_dot2c_f32_bf16 v32, v244, v57
    v_dot2c_f32_bf16 v34, v245, v57
    v_dot2c_f32_bf16 v36, v246, v57
    v_dot2c_f32_bf16 v38, v247, v57
    v_lshrrev_b32 v56, 16, v54
    v_dot2c_f32_bf16 v33, v248, v54
    v_dot2c_f32_bf16 v35, v249, v54
    v_dot2c_f32_bf16 v37, v250, v54
    v_dot2c_f32_bf16 v39, v251, v54
    v_dot2c_f32_bf16 v32, v248, v56
    v_dot2c_f32_bf16 v34, v249, v56
    v_dot2c_f32_bf16 v36, v250, v56
    v_dot2c_f32_bf16 v38, v251, v56
    v_lshrrev_b32 v57, 16, v55
    v_dot2c_f32_bf16 v33, v252, v55
    v_dot2c_f32_bf16 v35, v253, v55
    v_dot2c_f32_bf16 v37, v254, v55
    v_dot2c_f32_bf16 v39, v255, v55
    v_dot2c_f32_bf16 v32, v252, v57
    v_dot2c_f32_bf16 v34, v253, v57
    v_dot2c_f32_bf16 v36, v254, v57
    v_dot2c_f32_bf16 v38, v255, v57
    s_branch L_vdone
L_vdone:
    s_nop 4
    v_permlane16_swap_b32 v32, v33
    v_permlane16_swap_b32 v34, v35
    v_permlane16_swap_b32 v36, v37
    v_permlane16_swap_b32 v38, v39
    v_add_f32 v32, v32, v33
    v_add_f32 v34, v34, v35
    v_add_f32 v36, v36, v37
    v_add_f32 v38, v38, v39
    v_permlane32_swap_b32 v32, v34
    s_nop 0
    v_permlane32_swap_b32 v36, v38
    v_add_f32 v32, v32, v34
    v_add_f32 v36, v36, v38
    s_lshl_b32 s52, s69, 9
    v_add_u32 v18, s52, v31
    ds_add_f32 v18, v32 offset:20480
    ds_add_f32 v18, v36 offset:20496
    s_waitcnt lgkmcnt(0)
    s_barrier
    s_endpgm
L_helper:
    s_setprio 3
    s_memrealtime s[98:99]
    s_sub_u32 s64, s44, 4
    s_lshl_b32 s52, s64, 10
    v_add_u32 v7, s52, v2
    global_load_dwordx4 v[8:11], v7, s[4:5]
    s_lshl_b32 s52, s48, 8
    s_add_u32 s40, s10, s52
    s_addc_u32 s41, s11, 0
    s_sub_u32 s42, 0x400000, s52
    s_cmp_lg_u32 s50, 0
    s_cbranch_scc1 L_nopq
    s_lshl_b32 s53, s49, 20
    s_lshl_b32 s52, s64, 18
    s_add_u32 s53, s53, s52
    v_lshlrev_b32 v7, 16, v5
    v_lshl_add_u32 v7, v6, 4, v7
    buffer_load_dwordx4 v[128:131], v7, s[40:43], s53 offen nt
    s_add_u32 s53, s53, 8192
    buffer_load_dwordx4 v[132:135], v7, s[40:43], s53 offen nt
    s_add_u32 s53, s53, 8192
    buffer_load_dwordx4 v[136:139], v7, s[40:43], s53 offen nt
    s_add_u32 s53, s53, 8192
    buffer_load_dwordx4 v[140:143], v7, s[40:43], s53 offen nt
    s_add_u32 s53, s53, 8192
    buffer_load_dwordx4 v[144:147], v7, s[40:43], s53 offen nt
    s_add_u32 s53, s53, 8192
    buffer_load_dwordx4 v[148:151], v7, s[40:43], s53 offen nt
    s_add_u32 s53, s53, 8192
    buffer_load_dwordx4 v[152:155], v7, s[40:43], s53 offen nt
    s_add_u32 s53, s53, 8192
    buffer_load_dwordx4 v[156:159], v7, s[40:43], s53 offen nt
    s_add_u32 s53, s53, 8192
L_nopq:
    v_mov_b32 v12, 0
    v_mov_b32 v13, 0
    v_mov_b32 v14, 0
    v_mov_b32 v15, 0
    s_lshl_b32 s52, s64, 10
    v_add_u32 v16, s52, v2
    ds_write_b128 v16, v[12:15] offset:20480
    ds_write_b128 v12, v[12:15] offset:24704
    ds_write_b128 v12, v[12:15] offset:24720
    ds_write_b128 v2, v[12:15] offset:8192
    ds_write_b128 v2, v[12:15] offset:9216
    v_mov_b32 v63, 0
    s_waitcnt lgkmcnt(0)
    s_barrier
    s_cmp_lg_u32 s50, 0
    s_cbranch_scc1 L_wx0
    s_waitcnt vmcnt(8)
    s_branch L_wx1
L_wx0:
    s_waitcnt vmcnt(0)
L_wx1:
    v_lshlrev_b32 v16, 16, v8
    v_and_b32 v17, s61, v8
    v_lshlrev_b32 v18, 16, v9
    v_and_b32 v19, s61, v9
    v_lshlrev_b32 v20, 16, v10
    v_and_b32 v21, s61, v10
    v_lshlrev_b32 v22, 16, v11
    v_and_b32 v23, s61, v11
    v_add_f32 v24, v16, v17
    v_add_f32 v24, v24, v18
    v_add_f32 v24, v24, v19
    v_add_f32 v24, v24, v20
    v_add_f32 v24, v24, v21
    v_add_f32 v24, v24, v22
    v_add_f32 v24, v24, v23
    s_nop 1
    v_add_f32_dpp v24, v24, v24 row_ror:8 row_mask:0xf bank_mask:0xf
    s_nop 1
    v_add_f32_dpp v24, v24, v24 row_ror:4 row_mask:0xf bank_mask:0xf
    s_nop 1
    v_add_f32_dpp v24, v24, v24 row_ror:2 row_mask:0xf bank_mask:0xf
    s_nop 1
    v_add_f32_dpp v24, v24, v24 row_ror:1 row_mask:0xf bank_mask:0xf
    v_mov_b32 v25, v24
    s_nop 1
    v_permlane16_swap_b32 v24, v25
    v_add_f32 v24, v24, v25
    v_mov_b32 v25, v24
    s_nop 1
    v_permlane32_swap_b32 v24, v25
    v_add_f32 v24, v24, v25
    v_mul_f32 v24, 0x3b000000, v24
    v_sub_f32 v25, v16, v24
    v_mul_f32 v26, v25, v25
    v_sub_f32 v25, v17, v24
    v_fmac_f32 v26, v25, v25
    v_sub_f32 v25, v18, v24
    v_fmac_f32 v26, v25, v25
    v_sub_f32 v25, v19, v24
    v_fmac_f32 v26, v25, v25
    v_sub_f32 v25, v20, v24
    v_fmac_f32 v26, v25, v25
    v_sub_f32 v25, v21, v24
    v_fmac_f32 v26, v25, v25
    v_sub_f32 v25, v22, v24
    v_fmac_f32 v26, v25, v25
    v_sub_f32 v25, v23, v24
    v_fmac_f32 v26, v25, v25
    s_nop 1
    v_add_f32_dpp v26, v26, v26 row_ror:8 row_mask:0xf bank_mask:0xf
    s_nop 1
    v_add_f32_dpp v26, v26, v26 row_ror:4 row_mask:0xf bank_mask:0xf
    s_nop 1
    v_add_f32_dpp v26, v26, v26 row_ror:2 row_mask:0xf bank_mask:0xf
    s_nop 1
    v_add_f32_dpp v26, v26, v26 row_ror:1 row_mask:0xf bank_mask:0xf
    v_mov_b32 v25, v26
    s_nop 1
    v_permlane16_swap_b32 v26, v25
    v_add_f32 v26, v26, v25
    v_mov_b32 v25, v26
    s_nop 1
    v_permlane32_swap_b32 v26, v25
    v_add_f32 v26, v26, v25
    v_mul_f32 v26, 0x3b000000, v26
    v_cvt_pk_bf16_f32 v24, v24, v24
    v_lshlrev_b32 v24, 16, v24
    v_cvt_pk_bf16_f32 v26, v26, v26
    v_lshlrev_b32 v26, 16, v26
    v_add_f32 v26, 0x3727c5ac, v26
    v_cvt_pk_bf16_f32 v26, v26, v26
    v_lshlrev_b32 v26, 16, v26
    v_sqrt_f32 v26, v26
    s_nop 0
    v_cvt_pk_bf16_f32 v26, v26, v26
    v_lshlrev_b32 v26, 16, v26
    v_rcp_f32 v27, v26
    v_sub_f32 v16, v16, v24
    v_sub_f32 v17, v17, v24
    v_cvt_pk_bf16_f32 v25, v16, v17
    v_lshlrev_b32 v16, 16, v25
    v_and_b32 v17, s61, v25
    v_sub_f32 v18, v18, v24
    v_sub_f32 v19, v19, v24
    v_cvt_pk_bf16_f32 v25, v18, v19
    v_lshlrev_b32 v18, 16, v25
    v_and_b32 v19, s61, v25
    v_sub_f32 v20, v20, v24
    v_sub_f32 v21, v21, v24
    v_cvt_pk_bf16_f32 v25, v20, v21
    v_lshlrev_b32 v20, 16, v25
    v_and_b32 v21, s61, v25
    v_sub_f32 v22, v22, v24
    v_sub_f32 v23, v23, v24
    v_cvt_pk_bf16_f32 v25, v22, v23
    v_lshlrev_b32 v22, 16, v25
    v_and_b32 v23, s61, v25
    v_mul_f32 v28, v16, v27
    v_fma_f32 v29, -v28, v26, v16
    v_fma_f32 v16, v29, v27, v28
    v_mul_f32 v28, v17, v27
    v_fma_f32 v29, -v28, v26, v17
    v_fma_f32 v17, v29, v27, v28
    v_mul_f32 v28, v18, v27
    v_fma_f32 v29, -v28, v26, v18
    v_fma_f32 v18, v29, v27, v28
    v_mul_f32 v28, v19, v27
    v_fma_f32 v29, -v28, v26, v19
    v_fma_f32 v19, v29, v27, v28
    v_mul_f32 v28, v20, v27
    v_fma_f32 v29, -v28, v26, v20
    v_fma_f32 v20, v29, v27, v28
    v_mul_f32 v28, v21, v27
    v_fma_f32 v29, -v28, v26, v21
    v_fma_f32 v21, v29, v27, v28
    v_mul_f32 v28, v22, v27
    v_fma_f32 v29, -v28, v26, v22
    v_fma_f32 v22, v29, v27, v28
    v_mul_f32 v28, v23, v27
    v_fma_f32 v29, -v28, v26, v23
    v_fma_f32 v23, v29, v27, v28
    v_cvt_pk_bf16_f32 v8, v16, v17
    v_cvt_pk_bf16_f32 v9, v18, v19
    v_cvt_pk_bf16_f32 v10, v20, v21
    v_cvt_pk_bf16_f32 v11, v22, v23
    v_lshlrev_b32 v16, 16, v8
    v_and_b32 v17, s61, v8
    v_lshlrev_b32 v18, 16, v9
    v_and_b32 v19, s61, v9
    v_lshlrev_b32 v20, 16, v10
    v_and_b32 v21, s61, v10
    v_lshlrev_b32 v22, 16, v11
    v_and_b32 v23, s61, v11
    v_lshlrev_b32 v7, 5, v1
    s_lshl_b32 s52, s64, 11
    v_add_u32 v7, s52, v7
    ds_write_b128 v7, v[16:19] offset:0
    ds_write_b128 v7, v[20:23] offset:16
    v_mov_b32 v12, 1
    s_mov_b64 exec, 1
    ds_add_u32 v63, v12 offset:24712
    s_mov_b64 exec, -1
    s_cmp_lg_u32 s50, 0
    s_cbranch_scc1 L_pubx
    s_mov_b32 s65, 0
L_spc1a:
    ds_read_b32 v12, v63 offset:24712
    s_waitcnt lgkmcnt(0)
    v_readfirstlane_b32 s52, v12
    s_add_u32 s65, s65, 1
    s_cmp_gt_u32 s65, 1600000
    s_cbranch_scc1 L_spc1a_x
    s_cmp_lt_u32 s52, 4
    s_cbranch_scc1 L_spc1a
L_spc1a_x:
    s_lshl_b32 s52, s49, 9
    s_lshl_b32 s53, s64, 7
    s_add_u32 s52, s52, s53
    v_lshlrev_b32 v7, 5, v5
    v_add_u32 v7, s52, v7
    ds_read_b128 v[64:67], v7 offset:0
    ds_read_b128 v[68:71], v7 offset:16
    ds_read_b128 v[72:75], v7 offset:2048
    ds_read_b128 v[76:79], v7 offset:2064
    ds_read_b128 v[80:83], v7 offset:4096
    ds_read_b128 v[84:87], v7 offset:4112
    ds_read_b128 v[88:91], v7 offset:6144
    ds_read_b128 v[92:95], v7 offset:6160
    v_mov_b32 v96, 0
    v_mov_b32 v97, 0
    v_mov_b32 v98, 0
    v_mov_b32 v99, 0
    v_mov_b32 v100, 0
    v_mov_b32 v101, 0
    v_mov_b32 v102, 0
    v_mov_b32 v103, 0
    v_mov_b32 v104, 0
    v_mov_b32 v105, 0
    v_mov_b32 v106, 0
    v_mov_b32 v107, 0
    v_mov_b32 v108, 0
    v_mov_b32 v109, 0
    v_mov_b32 v110, 0
    v_mov_b32 v111, 0
    v_mov_b32 v112, 0
    v_mov_b32 v113, 0
    v_mov_b32 v114, 0
    v_mov_b32 v115, 0
    v_mov_b32 v116, 0
    v_mov_b32 v117, 0
    v_mov_b32 v118, 0
    v_mov_b32 v119, 0
    v_mov_b32 v120, 0
    v_mov_b32 v121, 0
    v_mov_b32 v122, 0
    v_mov_b32 v123, 0
    v_mov_b32 v124, 0
    v_mov_b32 v125, 0
    v_mov_b32 v126, 0
    v_mov_b32 v127, 0
    s_waitcnt lgkmcnt(0)
    s_waitcnt vmcnt(7)
    v_lshrrev_b32 v30, 16, v64
    v_dot2c_f32_bf16 v97, v128, v64
    v_dot2c_f32_bf16 v99, v129, v64
    v_dot2c_f32_bf16 v101, v130, v64
    v_dot2c_f32_bf16 v103, v131, v64
    v_dot2c_f32_bf16 v96, v128, v30
    v_dot2c_f32_bf16 v98, v129, v30
    v_dot2c_f32_bf16 v100, v130, v30
    v_dot2c_f32_bf16 v102, v131, v30
    v_lshrrev_b32 v31, 16, v72
    v_dot2c_f32_bf16 v105, v128, v72
    v_dot2c_f32_bf16 v107, v129, v72
    v_dot2c_f32_bf16 v109, v130, v72
    v_dot2c_f32_bf16 v111, v131, v72
    v_dot2c_f32_bf16 v104, v128, v31
    v_dot2c_f32_bf16 v106, v129, v31
    v_dot2c_f32_bf16 v108, v130, v31
    v_dot2c_f32_bf16 v110, v131, v31
    v_lshrrev_b32 v30, 16, v80
    v_dot2c_f32_bf16 v113, v128, v80
    v_dot2c_f32_bf16 v115, v129, v80
    v_dot2c_f32_bf16 v117, v130, v80
    v_dot2c_f32_bf16 v119, v131, v80
    v_dot2c_f32_bf16 v112, v128, v30
    v_dot2c_f32_bf16 v114, v129, v30
    v_dot2c_f32_bf16 v116, v130, v30
    v_dot2c_f32_bf16 v118, v131, v30
    v_lshrrev_b32 v31, 16, v88
    v_dot2c_f32_bf16 v121, v128, v88
    v_dot2c_f32_bf16 v123, v129, v88
    v_dot2c_f32_bf16 v125, v130, v88
    v_dot2c_f32_bf16 v127, v131, v88
    v_dot2c_f32_bf16 v120, v128, v31
    v_dot2c_f32_bf16 v122, v129, v31
    v_dot2c_f32_bf16 v124, v130, v31
    v_dot2c_f32_bf16 v126, v131, v31
    s_waitcnt vmcnt(6)
    v_lshrrev_b32 v30, 16, v65
    v_dot2c_f32_bf16 v97, v132, v65
    v_dot2c_f32_bf16 v99, v133, v65
    v_dot2c_f32_bf16 v101, v134, v65
    v_dot2c_f32_bf16 v103, v135, v65
    v_dot2c_f32_bf16 v96, v132, v30
    v_dot2c_f32_bf16 v98, v133, v30
    v_dot2c_f32_bf16 v100, v134, v30
    v_dot2c_f32_bf16 v102, v135, v30
    v_lshrrev_b32 v31, 16, v73
    v_dot2c_f32_bf16 v105, v132, v73
    v_dot2c_f32_bf16 v107, v133, v73
    v_dot2c_f32_bf16 v109, v134, v73
    v_dot2c_f32_bf16 v111, v135, v73
    v_dot2c_f32_bf16 v104, v132, v31
    v_dot2c_f32_bf16 v106, v133, v31
    v_dot2c_f32_bf16 v108, v134, v31
    v_dot2c_f32_bf16 v110, v135, v31
    v_lshrrev_b32 v30, 16, v81
    v_dot2c_f32_bf16 v113, v132, v81
    v_dot2c_f32_bf16 v115, v133, v81
    v_dot2c_f32_bf16 v117, v134, v81
    v_dot2c_f32_bf16 v119, v135, v81
    v_dot2c_f32_bf16 v112, v132, v30
    v_dot2c_f32_bf16 v114, v133, v30
    v_dot2c_f32_bf16 v116, v134, v30
    v_dot2c_f32_bf16 v118, v135, v30
    v_lshrrev_b32 v31, 16, v89
    v_dot2c_f32_bf16 v121, v132, v89
    v_dot2c_f32_bf16 v123, v133, v89
    v_dot2c_f32_bf16 v125, v134, v89
    v_dot2c_f32_bf16 v127, v135, v89
    v_dot2c_f32_bf16 v120, v132, v31
    v_dot2c_f32_bf16 v122, v133, v31
    v_dot2c_f32_bf16 v124, v134, v31
    v_dot2c_f32_bf16 v126, v135, v31
    s_waitcnt vmcnt(5)
    v_lshrrev_b32 v30, 16, v66
    v_dot2c_f32_bf16 v97, v136, v66
    v_dot2c_f32_bf16 v99, v137, v66
    v_dot2c_f32_bf16 v101, v138, v66
    v_dot2c_f32_bf16 v103, v139, v66
    v_dot2c_f32_bf16 v96, v136, v30
    v_dot2c_f32_bf16 v98, v137, v30
    v_dot2c_f32_bf16 v100, v138, v30
    v_dot2c_f32_bf16 v102, v139, v30
    v_lshrrev_b32 v31, 16, v74
    v_dot2c_f32_bf16 v105, v136, v74
    v_dot2c_f32_bf16 v107, v137, v74
    v_dot2c_f32_bf16 v109, v138, v74
    v_dot2c_f32_bf16 v111, v139, v74
    v_dot2c_f32_bf16 v104, v136, v31
    v_dot2c_f32_bf16 v106, v137, v31
    v_dot2c_f32_bf16 v108, v138, v31
    v_dot2c_f32_bf16 v110, v139, v31
    v_lshrrev_b32 v30, 16, v82
    v_dot2c_f32_bf16 v113, v136, v82
    v_dot2c_f32_bf16 v115, v137, v82
    v_dot2c_f32_bf16 v117, v138, v82
    v_dot2c_f32_bf16 v119, v139, v82
    v_dot2c_f32_bf16 v112, v136, v30
    v_dot2c_f32_bf16 v114, v137, v30
    v_dot2c_f32_bf16 v116, v138, v30
    v_dot2c_f32_bf16 v118, v139, v30
    v_lshrrev_b32 v31, 16, v90
    v_dot2c_f32_bf16 v121, v136, v90
    v_dot2c_f32_bf16 v123, v137, v90
    v_dot2c_f32_bf16 v125, v138, v90
    v_dot2c_f32_bf16 v127, v139, v90
    v_dot2c_f32_bf16 v120, v136, v31
    v_dot2c_f32_bf16 v122, v137, v31
    v_dot2c_f32_bf16 v124, v138, v31
    v_dot2c_f32_bf16 v126, v139, v31
    s_waitcnt vmcnt(4)
    v_lshrrev_b32 v30, 16, v67
    v_dot2c_f32_bf16 v97, v140, v67
    v_dot2c_f32_bf16 v99, v141, v67
    v_dot2c_f32_bf16 v101, v142, v67
    v_dot2c_f32_bf16 v103, v143, v67
    v_dot2c_f32_bf16 v96, v140, v30
    v_dot2c_f32_bf16 v98, v141, v30
    v_dot2c_f32_bf16 v100, v142, v30
    v_dot2c_f32_bf16 v102, v143, v30
    v_lshrrev_b32 v31, 16, v75
    v_dot2c_f32_bf16 v105, v140, v75
    v_dot2c_f32_bf16 v107, v141, v75
    v_dot2c_f32_bf16 v109, v142, v75
    v_dot2c_f32_bf16 v111, v143, v75
    v_dot2c_f32_bf16 v104, v140, v31
    v_dot2c_f32_bf16 v106, v141, v31
    v_dot2c_f32_bf16 v108, v142, v31
    v_dot2c_f32_bf16 v110, v143, v31
    v_lshrrev_b32 v30, 16, v83
    v_dot2c_f32_bf16 v113, v140, v83
    v_dot2c_f32_bf16 v115, v141, v83
    v_dot2c_f32_bf16 v117, v142, v83
    v_dot2c_f32_bf16 v119, v143, v83
    v_dot2c_f32_bf16 v112, v140, v30
    v_dot2c_f32_bf16 v114, v141, v30
    v_dot2c_f32_bf16 v116, v142, v30
    v_dot2c_f32_bf16 v118, v143, v30
    v_lshrrev_b32 v31, 16, v91
    v_dot2c_f32_bf16 v121, v140, v91
    v_dot2c_f32_bf16 v123, v141, v91
    v_dot2c_f32_bf16 v125, v142, v91
    v_dot2c_f32_bf16 v127, v143, v91
    v_dot2c_f32_bf16 v120, v140, v31
    v_dot2c_f32_bf16 v122, v141, v31
    v_dot2c_f32_bf16 v124, v142, v31
    v_dot2c_f32_bf16 v126, v143, v31
    s_waitcnt vmcnt(3)
    v_lshrrev_b32 v30, 16, v68
    v_dot2c_f32_bf16 v97, v144, v68
    v_dot2c_f32_bf16 v99, v145, v68
    v_dot2c_f32_bf16 v101, v146, v68
    v_dot2c_f32_bf16 v103, v147, v68
    v_dot2c_f32_bf16 v96, v144, v30
    v_dot2c_f32_bf16 v98, v145, v30
    v_dot2c_f32_bf16 v100, v146, v30
    v_dot2c_f32_bf16 v102, v147, v30
    v_lshrrev_b32 v31, 16, v76
    v_dot2c_f32_bf16 v105, v144, v76
    v_dot2c_f32_bf16 v107, v145, v76
    v_dot2c_f32_bf16 v109, v146, v76
    v_dot2c_f32_bf16 v111, v147, v76
    v_dot2c_f32_bf16 v104, v144, v31
    v_dot2c_f32_bf16 v106, v145, v31
    v_dot2c_f32_bf16 v108, v146, v31
    v_dot2c_f32_bf16 v110, v147, v31
    v_lshrrev_b32 v30, 16, v84
    v_dot2c_f32_bf16 v113, v144, v84
    v_dot2c_f32_bf16 v115, v145, v84
    v_dot2c_f32_bf16 v117, v146, v84
    v_dot2c_f32_bf16 v119, v147, v84
    v_dot2c_f32_bf16 v112, v144, v30
    v_dot2c_f32_bf16 v114, v145, v30
    v_dot2c_f32_bf16 v116, v146, v30
    v_dot2c_f32_bf16 v118, v147, v30
    v_lshrrev_b32 v31, 16, v92
    v_dot2c_f32_bf16 v121, v144, v92
    v_dot2c_f32_bf16 v123, v145, v92
    v_dot2c_f32_bf16 v125, v146, v92
    v_dot2c_f32_bf16 v127, v147, v92
    v_dot2c_f32_bf16 v120, v144, v31
    v_dot2c_f32_bf16 v122, v145, v31
    v_dot2c_f32_bf16 v124, v146, v31
    v_dot2c_f32_bf16 v126, v147, v31
    s_waitcnt vmcnt(2)
    v_lshrrev_b32 v30, 16, v69
    v_dot2c_f32_bf16 v97, v148, v69
    v_dot2c_f32_bf16 v99, v149, v69
    v_dot2c_f32_bf16 v101, v150, v69
    v_dot2c_f32_bf16 v103, v151, v69
    v_dot2c_f32_bf16 v96, v148, v30
    v_dot2c_f32_bf16 v98, v149, v30
    v_dot2c_f32_bf16 v100, v150, v30
    v_dot2c_f32_bf16 v102, v151, v30
    v_lshrrev_b32 v31, 16, v77
    v_dot2c_f32_bf16 v105, v148, v77
    v_dot2c_f32_bf16 v107, v149, v77
    v_dot2c_f32_bf16 v109, v150, v77
    v_dot2c_f32_bf16 v111, v151, v77
    v_dot2c_f32_bf16 v104, v148, v31
    v_dot2c_f32_bf16 v106, v149, v31
    v_dot2c_f32_bf16 v108, v150, v31
    v_dot2c_f32_bf16 v110, v151, v31
    v_lshrrev_b32 v30, 16, v85
    v_dot2c_f32_bf16 v113, v148, v85
    v_dot2c_f32_bf16 v115, v149, v85
    v_dot2c_f32_bf16 v117, v150, v85
    v_dot2c_f32_bf16 v119, v151, v85
    v_dot2c_f32_bf16 v112, v148, v30
    v_dot2c_f32_bf16 v114, v149, v30
    v_dot2c_f32_bf16 v116, v150, v30
    v_dot2c_f32_bf16 v118, v151, v30
    v_lshrrev_b32 v31, 16, v93
    v_dot2c_f32_bf16 v121, v148, v93
    v_dot2c_f32_bf16 v123, v149, v93
    v_dot2c_f32_bf16 v125, v150, v93
    v_dot2c_f32_bf16 v127, v151, v93
    v_dot2c_f32_bf16 v120, v148, v31
    v_dot2c_f32_bf16 v122, v149, v31
    v_dot2c_f32_bf16 v124, v150, v31
    v_dot2c_f32_bf16 v126, v151, v31
    s_waitcnt vmcnt(1)
    v_lshrrev_b32 v30, 16, v70
    v_dot2c_f32_bf16 v97, v152, v70
    v_dot2c_f32_bf16 v99, v153, v70
    v_dot2c_f32_bf16 v101, v154, v70
    v_dot2c_f32_bf16 v103, v155, v70
    v_dot2c_f32_bf16 v96, v152, v30
    v_dot2c_f32_bf16 v98, v153, v30
    v_dot2c_f32_bf16 v100, v154, v30
    v_dot2c_f32_bf16 v102, v155, v30
    v_lshrrev_b32 v31, 16, v78
    v_dot2c_f32_bf16 v105, v152, v78
    v_dot2c_f32_bf16 v107, v153, v78
    v_dot2c_f32_bf16 v109, v154, v78
    v_dot2c_f32_bf16 v111, v155, v78
    v_dot2c_f32_bf16 v104, v152, v31
    v_dot2c_f32_bf16 v106, v153, v31
    v_dot2c_f32_bf16 v108, v154, v31
    v_dot2c_f32_bf16 v110, v155, v31
    v_lshrrev_b32 v30, 16, v86
    v_dot2c_f32_bf16 v113, v152, v86
    v_dot2c_f32_bf16 v115, v153, v86
    v_dot2c_f32_bf16 v117, v154, v86
    v_dot2c_f32_bf16 v119, v155, v86
    v_dot2c_f32_bf16 v112, v152, v30
    v_dot2c_f32_bf16 v114, v153, v30
    v_dot2c_f32_bf16 v116, v154, v30
    v_dot2c_f32_bf16 v118, v155, v30
    v_lshrrev_b32 v31, 16, v94
    v_dot2c_f32_bf16 v121, v152, v94
    v_dot2c_f32_bf16 v123, v153, v94
    v_dot2c_f32_bf16 v125, v154, v94
    v_dot2c_f32_bf16 v127, v155, v94
    v_dot2c_f32_bf16 v120, v152, v31
    v_dot2c_f32_bf16 v122, v153, v31
    v_dot2c_f32_bf16 v124, v154, v31
    v_dot2c_f32_bf16 v126, v155, v31
    s_waitcnt vmcnt(0)
    v_lshrrev_b32 v30, 16, v71
    v_dot2c_f32_bf16 v97, v156, v71
    v_dot2c_f32_bf16 v99, v157, v71
    v_dot2c_f32_bf16 v101, v158, v71
    v_dot2c_f32_bf16 v103, v159, v71
    v_dot2c_f32_bf16 v96, v156, v30
    v_dot2c_f32_bf16 v98, v157, v30
    v_dot2c_f32_bf16 v100, v158, v30
    v_dot2c_f32_bf16 v102, v159, v30
    v_lshrrev_b32 v31, 16, v79
    v_dot2c_f32_bf16 v105, v156, v79
    v_dot2c_f32_bf16 v107, v157, v79
    v_dot2c_f32_bf16 v109, v158, v79
    v_dot2c_f32_bf16 v111, v159, v79
    v_dot2c_f32_bf16 v104, v156, v31
    v_dot2c_f32_bf16 v106, v157, v31
    v_dot2c_f32_bf16 v108, v158, v31
    v_dot2c_f32_bf16 v110, v159, v31
    v_lshrrev_b32 v30, 16, v87
    v_dot2c_f32_bf16 v113, v156, v87
    v_dot2c_f32_bf16 v115, v157, v87
    v_dot2c_f32_bf16 v117, v158, v87
    v_dot2c_f32_bf16 v119, v159, v87
    v_dot2c_f32_bf16 v112, v156, v30
    v_dot2c_f32_bf16 v114, v157, v30
    v_dot2c_f32_bf16 v116, v158, v30
    v_dot2c_f32_bf16 v118, v159, v30
    v_lshrrev_b32 v31, 16, v95
    v_dot2c_f32_bf16 v121, v156, v95
    v_dot2c_f32_bf16 v123, v157, v95
    v_dot2c_f32_bf16 v125, v158, v95
    v_dot2c_f32_bf16 v127, v159, v95
    v_dot2c_f32_bf16 v120, v156, v31
    v_dot2c_f32_bf16 v122, v157, v31
    v_dot2c_f32_bf16 v124, v158, v31
    v_dot2c_f32_bf16 v126, v159, v31
    v_permlane16_swap_b32 v96, v97
    v_permlane16_swap_b32 v98, v99
    v_permlane16_swap_b32 v100, v101
    v_permlane16_swap_b32 v102, v103
    v_add_f32 v96, v96, v97
    v_add_f32 v98, v98, v99
    v_add_f32 v100, v100, v101
    v_add_f32 v102, v102, v103
    v_permlane32_swap_b32 v96, v98
    s_nop 0
    v_permlane32_swap_b32 v100, v102
    v_add_f32 v96, v96, v98
    v_add_f32 v100, v100, v102
    v_permlane16_swap_b32 v104, v105
    v_permlane16_swap_b32 v106, v107
    v_permlane16_swap_b32 v108, v109
    v_permlane16_swap_b32 v110, v111
    v_add_f32 v104, v104, v105
    v_add_f32 v106, v106, v107
    v_add_f32 v108, v108, v109
    v_add_f32 v110, v110, v111
    v_permlane32_swap_b32 v104, v106
    s_nop 0
    v_permlane32_swap_b32 v108, v110
    v_add_f32 v104, v104, v106
    v_add_f32 v108, v108, v110
    v_permlane16_swap_b32 v112, v113
    v_permlane16_swap_b32 v114, v115
    v_permlane16_swap_b32 v116, v117
    v_permlane16_swap_b32 v118, v119
    v_add_f32 v112, v112, v113
    v_add_f32 v114, v114, v115
    v_add_f32 v116, v116, v117
    v_add_f32 v118, v118, v119
    v_permlane32_swap_b32 v112, v114
    s_nop 0
    v_permlane32_swap_b32 v116, v118
    v_add_f32 v112, v112, v114
    v_add_f32 v116, v116, v118
    v_permlane16_swap_b32 v120, v121
    v_permlane16_swap_b32 v122, v123
    v_permlane16_swap_b32 v124, v125
    v_permlane16_swap_b32 v126, v127
    v_add_f32 v120, v120, v121
    v_add_f32 v122, v122, v123
    v_add_f32 v124, v124, v125
    v_add_f32 v126, v126, v127
    v_permlane32_swap_b32 v120, v122
    s_nop 0
    v_permlane32_swap_b32 v124, v126
    v_add_f32 v120, v120, v122
    v_add_f32 v124, v124, v126
    v_lshlrev_b32 v7, 5, v6
    v_lshl_add_u32 v7, v5, 2, v7
    ds_add_f32 v7, v96 offset:8192
    ds_add_f32 v7, v100 offset:8208
    ds_add_f32 v7, v104 offset:8704
    ds_add_f32 v7, v108 offset:8720
    ds_add_f32 v7, v112 offset:9216
    ds_add_f32 v7, v116 offset:9232
    ds_add_f32 v7, v120 offset:9728
    ds_add_f32 v7, v124 offset:9744
    v_mov_b32 v12, 1
    s_mov_b64 exec, 1
    ds_add_rtn_u32 v13, v63, v12 offset:24716
    s_mov_b64 exec, -1
    s_waitcnt lgkmcnt(0)
    v_readfirstlane_b32 s52, v13
    s_nop 0
    s_cmp_lg_u32 s52, 3
    s_cbranch_scc1 L_pubx
    ds_read_b128 v[16:19], v2 offset:8192
    ds_read_b128 v[20:23], v2 offset:9216
    s_lshl_b32 s52, s48, 2
    s_add_u32 s52, s52, s49
    s_add_u32 s54, s52, 128
    s_lshl_b32 s52, s52, 11
    s_add_u32 s52, s52, 3407872
    s_getreg_b32 s53, hwreg(HW_REG_XCC_ID)
    s_and_b32 s53, s53, 15
    s_or_b32 s53, s53, 0x80
    v_mov_b32 v12, s53
    v_mov_b32 v13, s54
    s_waitcnt lgkmcnt(0)
    buffer_store_dwordx4 v[16:19], v2, s[36:39], s52 offen
    buffer_store_dwordx4 v[20:23], v2, s[36:39], s52 offen offset:1024
    s_mov_b64 exec, 1
    s_waitcnt vmcnt(0)
    global_store_byte v13, v12, s[24:25]
    s_mov_b64 exec, -1
L_pubx:
    s_cmp_lg_u32 s64, 0
    s_cbranch_scc1 L_waitdec
    s_getreg_b32 s53, hwreg(HW_REG_XCC_ID)
    s_and_b32 s53, s53, 15
    s_or_b32 s53, s53, 0x80
    s_mul_i32 s53, s53, 0x01010101
    s_lshl_b32 s52, s48, 2
    s_add_u32 s52, s52, 128
    v_mov_b32 v13, s52
L_qf:
    global_load_dword v12, v13, s[24:25] sc1
    s_memrealtime s[54:55]
    s_waitcnt vmcnt(0) lgkmcnt(0)
    v_readfirstlane_b32 s52, v12
    s_nop 0
    s_cmp_eq_u32 s52, s53
    s_cbranch_scc1 L_qok
    s_sub_u32 s54, s54, s98
    s_cmp_lt_u32 s54, 1000
    s_cbranch_scc1 L_qf
    v_mov_b32 v12, 2
    ds_write_b32 v63, v12 offset:24720
    s_branch L_qfb
L_qok:
    v_mov_b32 v12, 1
    ds_write_b32 v63, v12 offset:24720
    v_lshrrev_b32 v14, 5, v1
    v_and_b32 v15, 31, v1
    v_lshlrev_b32 v14, 11, v14
    v_lshl_add_u32 v14, v15, 4, v14
    s_lshl_b32 s52, s48, 13
    s_lshl_b32 s53, s49, 9
    s_add_u32 s52, s52, s53
    s_add_u32 s52, s52, 3407872
    s_add_u32 s53, s52, 4096
    buffer_load_dwordx4 v[16:19], v14, s[36:39], s52 offen sc1
    buffer_load_dwordx4 v[20:23], v14, s[36:39], s53 offen sc1
    s_waitcnt vmcnt(1)
    ds_write_b128 v2, v[16:19] offset:18432
    s_waitcnt vmcnt(0)
    ds_write_b128 v2, v[20:23] offset:19456
    s_branch L_qdone
L_waitdec:
    s_mov_b32 s65, 0
L_spdec:
    ds_read_b32 v12, v63 offset:24720
    s_waitcnt lgkmcnt(0)
    v_readfirstlane_b32 s52, v12
    s_add_u32 s65, s65, 1
    s_cmp_gt_u32 s65, 1600000
    s_cbranch_scc1 L_spdec_x
    s_cmp_lt_u32 s52, 1
    s_cbranch_scc1 L_spdec
L_spdec_x:
    s_cmp_eq_u32 s52, 1
    s_cbranch_scc1 L_qdone
L_qfb:
    s_lshl_b32 s53, s64, 20
    v_lshlrev_b32 v7, 18, v5
    v_lshl_add_u32 v7, v6, 4, v7
    buffer_load_dwordx4 v[128:131], v7, s[40:43], s53 offen nt
    s_add_u32 s53, s53, 8192
    buffer_load_dwordx4 v[132:135], v7, s[40:43], s53 offen nt
    s_add_u32 s53, s53, 8192
    buffer_load_dwordx4 v[136:139], v7, s[40:43], s53 offen nt
    s_add_u32 s53, s53, 8192
    buffer_load_dwordx4 v[140:143], v7, s[40:43], s53 offen nt
    s_add_u32 s53, s53, 8192
    buffer_load_dwordx4 v[144:147], v7, s[40:43], s53 offen nt
    s_add_u32 s53, s53, 8192
    buffer_load_dwordx4 v[148:151], v7, s[40:43], s53 offen nt
    s_add_u32 s53, s53, 8192
    buffer_load_dwordx4 v[152:155], v7, s[40:43], s53 offen nt
    s_add_u32 s53, s53, 8192
    buffer_load_dwordx4 v[156:159], v7, s[40:43], s53 offen nt
    s_add_u32 s53, s53, 8192
    buffer_load_dwordx4 v[160:163], v7, s[40:43], s53 offen nt
    s_add_u32 s53, s53, 8192
    buffer_load_dwordx4 v[164:167], v7, s[40:43], s53 offen nt
    s_add_u32 s53, s53, 8192
    buffer_load_dwordx4 v[168:171], v7, s[40:43], s53 offen nt
    s_add_u32 s53, s53, 8192
    buffer_load_dwordx4 v[172:175], v7, s[40:43], s53 offen nt
    s_add_u32 s53, s53, 8192
    buffer_load_dwordx4 v[176:179], v7, s[40:43], s53 offen nt
    s_add_u32 s53, s53, 8192
    buffer_load_dwordx4 v[180:183], v7, s[40:43], s53 offen nt
    s_add_u32 s53, s53, 8192
    buffer_load_dwordx4 v[184:187], v7, s[40:43], s53 offen nt
    s_add_u32 s53, s53, 8192
    buffer_load_dwordx4 v[188:191], v7, s[40:43], s53 offen nt
    s_add_u32 s53, s53, 8192
    buffer_load_dwordx4 v[192:195], v7, s[40:43], s53 offen nt
    s_add_u32 s53, s53, 8192
    buffer_load_dwordx4 v[196:199], v7, s[40:43], s53 offen nt
    s_add_u32 s53, s53, 8192
    buffer_load_dwordx4 v[200:203], v7, s[40:43], s53 offen nt
    s_add_u32 s53, s53, 8192
    buffer_load_dwordx4 v[204:207], v7, s[40:43], s53 offen nt
    s_add_u32 s53, s53, 8192
    buffer_load_dwordx4 v[208:211], v7, s[40:43], s53 offen nt
    s_add_u32 s53, s53, 8192
    buffer_load_dwordx4 v[212:215], v7, s[40:43], s53 offen nt
    s_add_u32 s53, s53, 8192
    buffer_load_dwordx4 v[216:219], v7, s[40:43], s53 offen nt
    s_add_u32 s53, s53, 8192
    buffer_load_dwordx4 v[220:223], v7, s[40:43], s53 offen nt
    s_add_u32 s53, s53, 8192
    buffer_load_dwordx4 v[224:227], v7, s[40:43], s53 offen nt
    s_add_u32 s53, s53, 8192
    buffer_load_dwordx4 v[228:231], v7, s[40:43], s53 offen nt
    s_add_u32 s53, s53, 8192
    buffer_load_dwordx4 v[232:235], v7, s[40:43], s53 offen nt
    s_add_u32 s53, s53, 8192
    buffer_load_dwordx4 v[236:239], v7, s[40:43], s53 offen nt
    s_add_u32 s53, s53, 8192
    buffer_load_dwordx4 v[240:243], v7, s[40:43], s53 offen nt
    s_add_u32 s53, s53, 8192
    buffer_load_dwordx4 v[244:247], v7, s[40:43], s53 offen nt
    s_add_u32 s53, s53, 8192
    buffer_load_dwordx4 v[248:251], v7, s[40:43], s53 offen nt
    s_add_u32 s53, s53, 8192
    buffer_load_dwordx4 v[252:255], v7, s[40:43], s53 offen nt
    s_mov_b32 s65, 0
L_spc1b:
    ds_read_b32 v12, v63 offset:24712
    s_waitcnt lgkmcnt(0)
    v_readfirstlane_b32 s52, v12
    s_add_u32 s65, s65, 1
    s_cmp_gt_u32 s65, 1600000
    s_cbranch_scc1 L_spc1b_x
    s_cmp_lt_u32 s52, 4
    s_cbranch_scc1 L_spc1b
L_spc1b_x:
    s_lshl_b32 s52, s64, 9
    s_lshl_b32 s53, s49, 11
    s_add_u32 s52, s52, s53
    v_lshlrev_b32 v7, 7, v5
    v_add_u32 v7, s52, v7
    ds_read_b128 v[64:67], v7 offset:0
    ds_read_b128 v[68:71], v7 offset:16
    ds_read_b128 v[72:75], v7 offset:32
    ds_read_b128 v[76:79], v7 offset:48
    ds_read_b128 v[80:83], v7 offset:64
    ds_read_b128 v[84:87], v7 offset:80
    ds_read_b128 v[88:91], v7 offset:96
    ds_read_b128 v[92:95], v7 offset:112
    v_mov_b32 v32, 0
    v_mov_b32 v33, 0
    v_mov_b32 v34, 0
    v_mov_b32 v35, 0
    v_mov_b32 v36, 0
    v_mov_b32 v37, 0
    v_mov_b32 v38, 0
    v_mov_b32 v39, 0
    s_waitcnt lgkmcnt(0)
    s_waitcnt vmcnt(28)
    v_lshrrev_b32 v30, 16, v64
    v_dot2c_f32_bf16 v33, v128, v64
    v_dot2c_f32_bf16 v35, v129, v64
    v_dot2c_f32_bf16 v37, v130, v64
    v_dot2c_f32_bf16 v39, v131, v64
    v_dot2c_f32_bf16 v32, v128, v30
    v_dot2c_f32_bf16 v34, v129, v30
    v_dot2c_f32_bf16 v36, v130, v30
    v_dot2c_f32_bf16 v38, v131, v30
    v_lshrrev_b32 v31, 16, v65
    v_dot2c_f32_bf16 v33, v132, v65
    v_dot2c_f32_bf16 v35, v133, v65
    v_dot2c_f32_bf16 v37, v134, v65
    v_dot2c_f32_bf16 v39, v135, v65
    v_dot2c_f32_bf16 v32, v132, v31
    v_dot2c_f32_bf16 v34, v133, v31
    v_dot2c_f32_bf16 v36, v134, v31
    v_dot2c_f32_bf16 v38, v135, v31
    v_lshrrev_b32 v30, 16, v66
    v_dot2c_f32_bf16 v33, v136, v66
    v_dot2c_f32_bf16 v35, v137, v66
    v_dot2c_f32_bf16 v37, v138, v66
    v_dot2c_f32_bf16 v39, v139, v66
    v_dot2c_f32_bf16 v32, v136, v30
    v_dot2c_f32_bf16 v34, v137, v30
    v_dot2c_f32_bf16 v36, v138, v30
    v_dot2c_f32_bf16 v38, v139, v30
    v_lshrrev_b32 v31, 16, v67
    v_dot2c_f32_bf16 v33, v140, v67
    v_dot2c_f32_bf16 v35, v141, v67
    v_dot2c_f32_bf16 v37, v142, v67
    v_dot2c_f32_bf16 v39, v143, v67
    v_dot2c_f32_bf16 v32, v140, v31
    v_dot2c_f32_bf16 v34, v141, v31
    v_dot2c_f32_bf16 v36, v142, v31
    v_dot2c_f32_bf16 v38, v143, v31
    s_waitcnt vmcnt(24)
    v_lshrrev_b32 v30, 16, v68
    v_dot2c_f32_bf16 v33, v144, v68
    v_dot2c_f32_bf16 v35, v145, v68
    v_dot2c_f32_bf16 v37, v146, v68
    v_dot2c_f32_bf16 v39, v147, v68
    v_dot2c_f32_bf16 v32, v144, v30
    v_dot2c_f32_bf16 v34, v145, v30
    v_dot2c_f32_bf16 v36, v146, v30
    v_dot2c_f32_bf16 v38, v147, v30
    v_lshrrev_b32 v31, 16, v69
    v_dot2c_f32_bf16 v33, v148, v69
    v_dot2c_f32_bf16 v35, v149, v69
    v_dot2c_f32_bf16 v37, v150, v69
    v_dot2c_f32_bf16 v39, v151, v69
    v_dot2c_f32_bf16 v32, v148, v31
    v_dot2c_f32_bf16 v34, v149, v31
    v_dot2c_f32_bf16 v36, v150, v31
    v_dot2c_f32_bf16 v38, v151, v31
    v_lshrrev_b32 v30, 16, v70
    v_dot2c_f32_bf16 v33, v152, v70
    v_dot2c_f32_bf16 v35, v153, v70
    v_dot2c_f32_bf16 v37, v154, v70
    v_dot2c_f32_bf16 v39, v155, v70
    v_dot2c_f32_bf16 v32, v152, v30
    v_dot2c_f32_bf16 v34, v153, v30
    v_dot2c_f32_bf16 v36, v154, v30
    v_dot2c_f32_bf16 v38, v155, v30
    v_lshrrev_b32 v31, 16, v71
    v_dot2c_f32_bf16 v33, v156, v71
    v_dot2c_f32_bf16 v35, v157, v71
    v_dot2c_f32_bf16 v37, v158, v71
    v_dot2c_f32_bf16 v39, v159, v71
    v_dot2c_f32_bf16 v32, v156, v31
    v_dot2c_f32_bf16 v34, v157, v31
    v_dot2c_f32_bf16 v36, v158, v31
    v_dot2c_f32_bf16 v38, v159, v31
    s_waitcnt vmcnt(20)
    v_lshrrev_b32 v30, 16, v72
    v_dot2c_f32_bf16 v33, v160, v72
    v_dot2c_f32_bf16 v35, v161, v72
    v_dot2c_f32_bf16 v37, v162, v72
    v_dot2c_f32_bf16 v39, v163, v72
    v_dot2c_f32_bf16 v32, v160, v30
    v_dot2c_f32_bf16 v34, v161, v30
    v_dot2c_f32_bf16 v36, v162, v30
    v_dot2c_f32_bf16 v38, v163, v30
    v_lshrrev_b32 v31, 16, v73
    v_dot2c_f32_bf16 v33, v164, v73
    v_dot2c_f32_bf16 v35, v165, v73
    v_dot2c_f32_bf16 v37, v166, v73
    v_dot2c_f32_bf16 v39, v167, v73
    v_dot2c_f32_bf16 v32, v164, v31
    v_dot2c_f32_bf16 v34, v165, v31
    v_dot2c_f32_bf16 v36, v166, v31
    v_dot2c_f32_bf16 v38, v167, v31
    v_lshrrev_b32 v30, 16, v74
    v_dot2c_f32_bf16 v33, v168, v74
    v_dot2c_f32_bf16 v35, v169, v74
    v_dot2c_f32_bf16 v37, v170, v74
    v_dot2c_f32_bf16 v39, v171, v74
    v_dot2c_f32_bf16 v32, v168, v30
    v_dot2c_f32_bf16 v34, v169, v30
    v_dot2c_f32_bf16 v36, v170, v30
    v_dot2c_f32_bf16 v38, v171, v30
    v_lshrrev_b32 v31, 16, v75
    v_dot2c_f32_bf16 v33, v172, v75
    v_dot2c_f32_bf16 v35, v173, v75
    v_dot2c_f32_bf16 v37, v174, v75
    v_dot2c_f32_bf16 v39, v175, v75
    v_dot2c_f32_bf16 v32, v172, v31
    v_dot2c_f32_bf16 v34, v173, v31
    v_dot2c_f32_bf16 v36, v174, v31
    v_dot2c_f32_bf16 v38, v175, v31
    s_waitcnt vmcnt(16)
    v_lshrrev_b32 v30, 16, v76
    v_dot2c_f32_bf16 v33, v176, v76
    v_dot2c_f32_bf16 v35, v177, v76
    v_dot2c_f32_bf16 v37, v178, v76
    v_dot2c_f32_bf16 v39, v179, v76
    v_dot2c_f32_bf16 v32, v176, v30
    v_dot2c_f32_bf16 v34, v177, v30
    v_dot2c_f32_bf16 v36, v178, v30
    v_dot2c_f32_bf16 v38, v179, v30
    v_lshrrev_b32 v31, 16, v77
    v_dot2c_f32_bf16 v33, v180, v77
    v_dot2c_f32_bf16 v35, v181, v77
    v_dot2c_f32_bf16 v37, v182, v77
    v_dot2c_f32_bf16 v39, v183, v77
    v_dot2c_f32_bf16 v32, v180, v31
    v_dot2c_f32_bf16 v34, v181, v31
    v_dot2c_f32_bf16 v36, v182, v31
    v_dot2c_f32_bf16 v38, v183, v31
    v_lshrrev_b32 v30, 16, v78
    v_dot2c_f32_bf16 v33, v184, v78
    v_dot2c_f32_bf16 v35, v185, v78
    v_dot2c_f32_bf16 v37, v186, v78
    v_dot2c_f32_bf16 v39, v187, v78
    v_dot2c_f32_bf16 v32, v184, v30
    v_dot2c_f32_bf16 v34, v185, v30
    v_dot2c_f32_bf16 v36, v186, v30
    v_dot2c_f32_bf16 v38, v187, v30
    v_lshrrev_b32 v31, 16, v79
    v_dot2c_f32_bf16 v33, v188, v79
    v_dot2c_f32_bf16 v35, v189, v79
    v_dot2c_f32_bf16 v37, v190, v79
    v_dot2c_f32_bf16 v39, v191, v79
    v_dot2c_f32_bf16 v32, v188, v31
    v_dot2c_f32_bf16 v34, v189, v31
    v_dot2c_f32_bf16 v36, v190, v31
    v_dot2c_f32_bf16 v38, v191, v31
    s_waitcnt vmcnt(12)
    v_lshrrev_b32 v30, 16, v80
    v_dot2c_f32_bf16 v33, v192, v80
    v_dot2c_f32_bf16 v35, v193, v80
    v_dot2c_f32_bf16 v37, v194, v80
    v_dot2c_f32_bf16 v39, v195, v80
    v_dot2c_f32_bf16 v32, v192, v30
    v_dot2c_f32_bf16 v34, v193, v30
    v_dot2c_f32_bf16 v36, v194, v30
    v_dot2c_f32_bf16 v38, v195, v30
    v_lshrrev_b32 v31, 16, v81
    v_dot2c_f32_bf16 v33, v196, v81
    v_dot2c_f32_bf16 v35, v197, v81
    v_dot2c_f32_bf16 v37, v198, v81
    v_dot2c_f32_bf16 v39, v199, v81
    v_dot2c_f32_bf16 v32, v196, v31
    v_dot2c_f32_bf16 v34, v197, v31
    v_dot2c_f32_bf16 v36, v198, v31
    v_dot2c_f32_bf16 v38, v199, v31
    v_lshrrev_b32 v30, 16, v82
    v_dot2c_f32_bf16 v33, v200, v82
    v_dot2c_f32_bf16 v35, v201, v82
    v_dot2c_f32_bf16 v37, v202, v82
    v_dot2c_f32_bf16 v39, v203, v82
    v_dot2c_f32_bf16 v32, v200, v30
    v_dot2c_f32_bf16 v34, v201, v30
    v_dot2c_f32_bf16 v36, v202, v30
    v_dot2c_f32_bf16 v38, v203, v30
    v_lshrrev_b32 v31, 16, v83
    v_dot2c_f32_bf16 v33, v204, v83
    v_dot2c_f32_bf16 v35, v205, v83
    v_dot2c_f32_bf16 v37, v206, v83
    v_dot2c_f32_bf16 v39, v207, v83
    v_dot2c_f32_bf16 v32, v204, v31
    v_dot2c_f32_bf16 v34, v205, v31
    v_dot2c_f32_bf16 v36, v206, v31
    v_dot2c_f32_bf16 v38, v207, v31
    s_waitcnt vmcnt(8)
    v_lshrrev_b32 v30, 16, v84
    v_dot2c_f32_bf16 v33, v208, v84
    v_dot2c_f32_bf16 v35, v209, v84
    v_dot2c_f32_bf16 v37, v210, v84
    v_dot2c_f32_bf16 v39, v211, v84
    v_dot2c_f32_bf16 v32, v208, v30
    v_dot2c_f32_bf16 v34, v209, v30
    v_dot2c_f32_bf16 v36, v210, v30
    v_dot2c_f32_bf16 v38, v211, v30
    v_lshrrev_b32 v31, 16, v85
    v_dot2c_f32_bf16 v33, v212, v85
    v_dot2c_f32_bf16 v35, v213, v85
    v_dot2c_f32_bf16 v37, v214, v85
    v_dot2c_f32_bf16 v39, v215, v85
    v_dot2c_f32_bf16 v32, v212, v31
    v_dot2c_f32_bf16 v34, v213, v31
    v_dot2c_f32_bf16 v36, v214, v31
    v_dot2c_f32_bf16 v38, v215, v31
    v_lshrrev_b32 v30, 16, v86
    v_dot2c_f32_bf16 v33, v216, v86
    v_dot2c_f32_bf16 v35, v217, v86
    v_dot2c_f32_bf16 v37, v218, v86
    v_dot2c_f32_bf16 v39, v219, v86
    v_dot2c_f32_bf16 v32, v216, v30
    v_dot2c_f32_bf16 v34, v217, v30
    v_dot2c_f32_bf16 v36, v218, v30
    v_dot2c_f32_bf16 v38, v219, v30
    v_lshrrev_b32 v31, 16, v87
    v_dot2c_f32_bf16 v33, v220, v87
    v_dot2c_f32_bf16 v35, v221, v87
    v_dot2c_f32_bf16 v37, v222, v87
    v_dot2c_f32_bf16 v39, v223, v87
    v_dot2c_f32_bf16 v32, v220, v31
    v_dot2c_f32_bf16 v34, v221, v31
    v_dot2c_f32_bf16 v36, v222, v31
    v_dot2c_f32_bf16 v38, v223, v31
    s_waitcnt vmcnt(4)
    v_lshrrev_b32 v30, 16, v88
    v_dot2c_f32_bf16 v33, v224, v88
    v_dot2c_f32_bf16 v35, v225, v88
    v_dot2c_f32_bf16 v37, v226, v88
    v_dot2c_f32_bf16 v39, v227, v88
    v_dot2c_f32_bf16 v32, v224, v30
    v_dot2c_f32_bf16 v34, v225, v30
    v_dot2c_f32_bf16 v36, v226, v30
    v_dot2c_f32_bf16 v38, v227, v30
    v_lshrrev_b32 v31, 16, v89
    v_dot2c_f32_bf16 v33, v228, v89
    v_dot2c_f32_bf16 v35, v229, v89
    v_dot2c_f32_bf16 v37, v230, v89
    v_dot2c_f32_bf16 v39, v231, v89
    v_dot2c_f32_bf16 v32, v228, v31
    v_dot2c_f32_bf16 v34, v229, v31
    v_dot2c_f32_bf16 v36, v230, v31
    v_dot2c_f32_bf16 v38, v231, v31
    v_lshrrev_b32 v30, 16, v90
    v_dot2c_f32_bf16 v33, v232, v90
    v_dot2c_f32_bf16 v35, v233, v90
    v_dot2c_f32_bf16 v37, v234, v90
    v_dot2c_f32_bf16 v39, v235, v90
    v_dot2c_f32_bf16 v32, v232, v30
    v_dot2c_f32_bf16 v34, v233, v30
    v_dot2c_f32_bf16 v36, v234, v30
    v_dot2c_f32_bf16 v38, v235, v30
    v_lshrrev_b32 v31, 16, v91
    v_dot2c_f32_bf16 v33, v236, v91
    v_dot2c_f32_bf16 v35, v237, v91
    v_dot2c_f32_bf16 v37, v238, v91
    v_dot2c_f32_bf16 v39, v239, v91
    v_dot2c_f32_bf16 v32, v236, v31
    v_dot2c_f32_bf16 v34, v237, v31
    v_dot2c_f32_bf16 v36, v238, v31
    v_dot2c_f32_bf16 v38, v239, v31
    s_waitcnt vmcnt(0)
    v_lshrrev_b32 v30, 16, v92
    v_dot2c_f32_bf16 v33, v240, v92
    v_dot2c_f32_bf16 v35, v241, v92
    v_dot2c_f32_bf16 v37, v242, v92
    v_dot2c_f32_bf16 v39, v243, v92
    v_dot2c_f32_bf16 v32, v240, v30
    v_dot2c_f32_bf16 v34, v241, v30
    v_dot2c_f32_bf16 v36, v242, v30
    v_dot2c_f32_bf16 v38, v243, v30
    v_lshrrev_b32 v31, 16, v93
    v_dot2c_f32_bf16 v33, v244, v93
    v_dot2c_f32_bf16 v35, v245, v93
    v_dot2c_f32_bf16 v37, v246, v93
    v_dot2c_f32_bf16 v39, v247, v93
    v_dot2c_f32_bf16 v32, v244, v31
    v_dot2c_f32_bf16 v34, v245, v31
    v_dot2c_f32_bf16 v36, v246, v31
    v_dot2c_f32_bf16 v38, v247, v31
    v_lshrrev_b32 v30, 16, v94
    v_dot2c_f32_bf16 v33, v248, v94
    v_dot2c_f32_bf16 v35, v249, v94
    v_dot2c_f32_bf16 v37, v250, v94
    v_dot2c_f32_bf16 v39, v251, v94
    v_dot2c_f32_bf16 v32, v248, v30
    v_dot2c_f32_bf16 v34, v249, v30
    v_dot2c_f32_bf16 v36, v250, v30
    v_dot2c_f32_bf16 v38, v251, v30
    v_lshrrev_b32 v31, 16, v95
    v_dot2c_f32_bf16 v33, v252, v95
    v_dot2c_f32_bf16 v35, v253, v95
    v_dot2c_f32_bf16 v37, v254, v95
    v_dot2c_f32_bf16 v39, v255, v95
    v_dot2c_f32_bf16 v32, v252, v31
    v_dot2c_f32_bf16 v34, v253, v31
    v_dot2c_f32_bf16 v36, v254, v31
    v_dot2c_f32_bf16 v38, v255, v31
    v_permlane16_swap_b32 v32, v33
    v_permlane16_swap_b32 v34, v35
    v_permlane16_swap_b32 v36, v37
    v_permlane16_swap_b32 v38, v39
    v_add_f32 v32, v32, v33
    v_add_f32 v34, v34, v35
    v_add_f32 v36, v36, v37
    v_add_f32 v38, v38, v39
    v_permlane32_swap_b32 v32, v34
    s_nop 0
    v_permlane32_swap_b32 v36, v38
    v_add_f32 v32, v32, v34
    v_add_f32 v36, v36, v38
    v_lshlrev_b32 v7, 5, v6
    v_lshl_add_u32 v7, v5, 2, v7
    s_lshl_b32 s52, s64, 9
    v_add_u32 v7, s52, v7
    ds_write_b32 v7, v32 offset:18432
    ds_write_b32 v7, v36 offset:18448
L_qdone:
    s_waitcnt lgkmcnt(0)
    s_barrier
    s_mov_b32 s66, s46
    s_cmp_eq_u32 s45, 0
    s_cselect_b32 s66, s66, -1
    s_cmp_lg_u32 s64, 0
    s_cbranch_scc1 L_noclear
    v_mov_b32 v8, -1
    v_mov_b32 v9, -1
    v_mov_b32 v10, -1
    v_mov_b32 v11, -1
    s_lshl_b32 s52, s48, 13
    s_and_b32 s53, s46, 7
    s_lshl_b32 s53, s53, 10
    s_add_u32 s52, s52, s53
    s_add_u32 s52, s52, 196608
    buffer_store_dwordx4 v[8:11], v2, s[36:39], s52 offen sc1
    s_mov_b32 exec_lo, -1
    s_mov_b32 exec_hi, 0
    s_lshl_b32 s52, s2, 9
    s_add_u32 s52, s52, 3145728
    buffer_store_dwordx4 v[8:11], v2, s[36:39], s52 offen sc1
    s_mov_b64 exec, 1
    s_lshl_b32 s52, s46, 7
    s_lshl_b32 s53, s45, 2
    s_add_u32 s52, s52, s53
    s_add_u32 s52, s52, 163840
    buffer_store_dword v8, v2, s[36:39], s52 offen sc1
    s_getreg_b32 s53, hwreg(HW_REG_XCC_ID)
    s_and_b32 s53, s53, 15
    v_mov_b32 v12, s53
    s_lshl_b32 s52, s48, 5
    s_and_b32 s53, s46, 7
    s_lshl_b32 s53, s53, 2
    s_add_u32 s52, s52, s53
    s_add_u32 s52, s52, 132096
    buffer_store_dword v12, v2, s[36:39], s52 offen sc1
    s_mov_b64 exec, 0xf
    s_lshl_b32 s52, s2, 7
    s_add_u32 s53, s52, 65536
    buffer_store_dwordx4 v[8:11], v2, s[36:39], s53 offen sc1
    s_mov_b64 exec, 0xff
    s_add_u32 s52, s52, 0
    buffer_store_dwordx4 v[8:11], v2, s[36:39], s52 offen sc1
    s_cmp_lg_u32 s45, 0
    s_cbranch_scc1 L_noclear2
    s_lshl_b32 s52, s46, 7
    s_add_u32 s52, s52, 458752
    buffer_store_dwordx4 v[8:11], v2, s[36:39], s52 offen sc1
    s_mov_b64 exec, -1
    s_lshl_b32 s52, s46, 13
    s_add_u32 s52, s52, 1572864
    s_add_u32 s53, s52, 4096
    buffer_store_dwordx4 v[8:11], v2, s[36:39], s52 offen sc1
    buffer_store_dwordx4 v[8:11], v2, s[36:39], s52 offen offset:1024 sc1
    buffer_store_dwordx4 v[8:11], v2, s[36:39], s52 offen offset:2048 sc1
    buffer_store_dwordx4 v[8:11], v2, s[36:39], s52 offen offset:3072 sc1
    buffer_store_dwordx4 v[8:11], v2, s[36:39], s53 offen sc1
    buffer_store_dwordx4 v[8:11], v2, s[36:39], s53 offen offset:1024 sc1
    buffer_store_dwordx4 v[8:11], v2, s[36:39], s53 offen offset:2048 sc1
    buffer_store_dwordx4 v[8:11], v2, s[36:39], s53 offen offset:3072 sc1
    s_mov_b64 exec, 1
    s_getreg_b32 s53, hwreg(HW_REG_XCC_ID)
    s_and_b32 s53, s53, 15
    v_mov_b32 v12, s53
    s_lshl_b32 s52, s46, 2
    s_add_u32 s52, s52, 131072
    buffer_store_dword v12, v2, s[36:39], s52 offen sc1
L_noclear2:
    s_mov_b64 exec, 1
    v_mov_b32 v12, 1
    v_mov_b32 v13, 0
    s_waitcnt vmcnt(0)
    global_atomic_add v13, v12, s[24:25]
    s_mov_b64 exec, -1
L_noclear:
    s_lshl_b32 s52, s48, 17
    s_and_b32 s53, s46, 7
    s_lshl_b32 s53, s53, 7
    s_add_u32 s52, s52, s53
    s_add_u32 s40, s12, s52
    s_addc_u32 s41, s13, 0
    s_sub_u32 s42, 0x400000, s52
    v_lshrrev_b32 v8, 3, v1
    v_and_b32 v9, 7, v1
    v_lshlrev_b32 v7, 10, v8
    v_lshl_add_u32 v7, v9, 4, v7
    s_lshl_b32 s53, s64, 15
    buffer_load_dwordx4 v[128:131], v7, s[40:43], s53 offen nt
    s_add_u32 s53, s53, 8192
    buffer_load_dwordx4 v[132:135], v7, s[40:43], s53 offen nt
    s_add_u32 s53, s53, 8192
    buffer_load_dwordx4 v[136:139], v7, s[40:43], s53 offen nt
    s_add_u32 s53, s53, 8192
    buffer_load_dwordx4 v[140:143], v7, s[40:43], s53 offen nt
    s_add_u32 s53, s53, 8192
    v_mul_u32_u24 v7, 160, v8
    v_lshl_add_u32 v7, v9, 4, v7
    s_mul_i32 s52, s64, 5120
    s_add_u32 s52, s52, 36608
    v_add_u32 v7, s52, v7
    s_waitcnt vmcnt(3)
    ds_write_b128 v7, v[128:131] offset:0
    s_waitcnt vmcnt(2)
    ds_write_b128 v7, v[132:135] offset:1280
    s_waitcnt vmcnt(1)
    ds_write_b128 v7, v[136:139] offset:2560
    s_waitcnt vmcnt(0)
    ds_write_b128 v7, v[140:143] offset:3840
    s_cmp_lg_u32 s45, 0
    s_cbranch_scc1 L_noffn
    s_lshl_b32 s52, s46, 5
    v_lshlrev_b32 v8, 10, v5
    v_lshl_add_u32 v8, v6, 1, v8
    v_add_u32 v8, s52, v8
    global_load_ushort v63, v8, s[4:5]
    s_cmp_ge_u32 s46, 28
    s_cbranch_scc1 L_noffn1
    s_waitcnt lgkmcnt(0)
    s_mov_b32 s40, s20
    s_mov_b32 s41, s21
    s_mov_b32 s42, 1835008
    v_lshlrev_b32 v7, 10, v5
    v_lshl_add_u32 v7, v6, 4, v7
    s_lshl_b32 s52, s46, 16
    s_lshl_b32 s53, s64, 8
    s_add_u32 s53, s53, s52
    buffer_load_dwordx4 v[64:67], v7, s[40:43], s53 offen nt
    s_add_u32 s53, s53, 4096
    buffer_load_dwordx4 v[68:71], v7, s[40:43], s53 offen nt
    s_add_u32 s53, s53, 4096
    buffer_load_dwordx4 v[72:75], v7, s[40:43], s53 offen nt
    s_add_u32 s53, s53, 4096
    buffer_load_dwordx4 v[76:79], v7, s[40:43], s53 offen nt
    s_add_u32 s53, s53, 4096
    buffer_load_dwordx4 v[80:83], v7, s[40:43], s53 offen nt
    s_add_u32 s53, s53, 4096
    buffer_load_dwordx4 v[84:87], v7, s[40:43], s53 offen nt
    s_add_u32 s53, s53, 4096
    buffer_load_dwordx4 v[88:91], v7, s[40:43], s53 offen nt
    s_add_u32 s53, s53, 4096
    buffer_load_dwordx4 v[92:95], v7, s[40:43], s53 offen nt
    s_add_u32 s53, s53, 4096
    buffer_load_dwordx4 v[96:99], v7, s[40:43], s53 offen nt
    s_add_u32 s53, s53, 4096
    buffer_load_dwordx4 v[100:103], v7, s[40:43], s53 offen nt
    s_add_u32 s53, s53, 4096
    buffer_load_dwordx4 v[104:107], v7, s[40:43], s53 offen nt
    s_add_u32 s53, s53, 4096
    buffer_load_dwordx4 v[108:111], v7, s[40:43], s53 offen nt
    s_add_u32 s53, s53, 4096
    buffer_load_dwordx4 v[112:115], v7, s[40:43], s53 offen nt
    s_add_u32 s53, s53, 4096
    buffer_load_dwordx4 v[116:119], v7, s[40:43], s53 offen nt
    s_add_u32 s53, s53, 4096
    buffer_load_dwordx4 v[120:123], v7, s[40:43], s53 offen nt
    s_add_u32 s53, s53, 4096
    buffer_load_dwordx4 v[124:127], v7, s[40:43], s53 offen nt
    s_add_u32 s53, s53, 4096
    v_lshrrev_b32 v8, 3, v1
    v_and_b32 v9, 7, v1
    v_mul_u32_u24 v7, 3584, v8
    v_lshl_add_u32 v7, v9, 4, v7
    s_mov_b32 s42, 1835008
    s_mov_b32 s40, s16
    s_mov_b32 s41, s17
    s_mul_i32 s53, s64, 458752
    s_lshl_b32 s52, s46, 7
    s_add_u32 s53, s53, s52
    buffer_load_dwordx4 v[128:131], v7, s[40:43], s53 offen nt
    s_add_u32 s53, s53, 28672
    buffer_load_dwordx4 v[132:135], v7, s[40:43], s53 offen nt
    s_add_u32 s53, s53, 28672
    buffer_load_dwordx4 v[136:139], v7, s[40:43], s53 offen nt
    s_add_u32 s53, s53, 28672
    buffer_load_dwordx4 v[140:143], v7, s[40:43], s53 offen nt
    s_add_u32 s53, s53, 28672
    buffer_load_dwordx4 v[144:147], v7, s[40:43], s53 offen nt
    s_add_u32 s53, s53, 28672
    buffer_load_dwordx4 v[148:151], v7, s[40:43], s53 offen nt
    s_add_u32 s53, s53, 28672
    buffer_load_dwordx4 v[152:155], v7, s[40:43], s53 offen nt
    s_add_u32 s53, s53, 28672
    buffer_load_dwordx4 v[156:159], v7, s[40:43], s53 offen nt
    s_add_u32 s53, s53, 28672
    buffer_load_dwordx4 v[160:163], v7, s[40:43], s53 offen nt
    s_add_u32 s53, s53, 28672
    buffer_load_dwordx4 v[164:167], v7, s[40:43], s53 offen nt
    s_add_u32 s53, s53, 28672
    buffer_load_dwordx4 v[168:171], v7, s[40:43], s53 offen nt
    s_add_u32 s53, s53, 28672
    buffer_load_dwordx4 v[172:175], v7, s[40:43], s53 offen nt
    s_add_u32 s53, s53, 28672
    buffer_load_dwordx4 v[176:179], v7, s[40:43], s53 offen nt
    s_add_u32 s53, s53, 28672
    buffer_load_dwordx4 v[180:183], v7, s[40:43], s53 offen nt
    s_add_u32 s53, s53, 28672
    buffer_load_dwordx4 v[184:187], v7, s[40:43], s53 offen nt
    s_add_u32 s53, s53, 28672
    buffer_load_dwordx4 v[188:191], v7, s[40:43], s53 offen nt
    s_add_u32 s53, s53, 28672
    s_mov_b32 s40, s18
    s_mov_b32 s41, s19
    s_mul_i32 s53, s64, 458752
    s_lshl_b32 s52, s46, 7
    s_add_u32 s53, s53, s52
    buffer_load_dwordx4 v[192:195], v7, s[40:43], s53 offen nt
    s_add_u32 s53, s53, 28672
    buffer_load_dwordx4 v[196:199], v7, s[40:43], s53 offen nt
    s_add_u32 s53, s53, 28672
    buffer_load_dwordx4 v[200:203], v7, s[40:43], s53 offen nt
    s_add_u32 s53, s53, 28672
    buffer_load_dwordx4 v[204:207], v7, s[40:43], s53 offen nt
    s_add_u32 s53, s53, 28672
    buffer_load_dwordx4 v[208:211], v7, s[40:43], s53 offen nt
    s_add_u32 s53, s53, 28672
    buffer_load_dwordx4 v[212:215], v7, s[40:43], s53 offen nt
    s_add_u32 s53, s53, 28672
    buffer_load_dwordx4 v[216:219], v7, s[40:43], s53 offen nt
    s_add_u32 s53, s53, 28672
    buffer_load_dwordx4 v[220:223], v7, s[40:43], s53 offen nt
    s_add_u32 s53, s53, 28672
    buffer_load_dwordx4 v[224:227], v7, s[40:43], s53 offen nt
    s_add_u32 s53, s53, 28672
    buffer_load_dwordx4 v[228:231], v7, s[40:43], s53 offen nt
    s_add_u32 s53, s53, 28672
    buffer_load_dwordx4 v[232:235], v7, s[40:43], s53 offen nt
    s_add_u32 s53, s53, 28672
    buffer_load_dwordx4 v[236:239], v7, s[40:43], s53 offen nt
    s_add_u32 s53, s53, 28672
    buffer_load_dwordx4 v[240:243], v7, s[40:43], s53 offen nt
    s_add_u32 s53, s53, 28672
    buffer_load_dwordx4 v[244:247], v7, s[40:43], s53 offen nt
    s_add_u32 s53, s53, 28672
    buffer_load_dwordx4 v[248:251], v7, s[40:43], s53 offen nt
    s_add_u32 s53, s53, 28672
    buffer_load_dwordx4 v[252:255], v7, s[40:43], s53 offen nt
    s_add_u32 s53, s53, 28672
    s_mul_i32 s52, s64, 9216
    s_add_u32 s52, s52, 57088
    v_mul_u32_u24 v10, 288, v5
    v_lshl_add_u32 v10, v6, 4, v10
    v_add_u32 v10, s52, v10
    v_mul_u32_u24 v11, 160, v8
    v_lshl_add_u32 v11, v9, 4, v11
    v_add_u32 v11, s52, v11
    v_lshrrev_b32 v12, 2, v6
    v_lshl_add_u32 v12, v5, 2, v12
    v_and_b32 v13, 3, v6
    v_lshlrev_b32 v13, 3, v13
    v_add_u32 v13, s52, v13
    v_mul_u32_u24 v14, 288, v12
    v_add_u32 v14, v14, v13
    v_mul_u32_u24 v15, 160, v12
    v_add_u32 v15, v15, v13
    s_waitcnt vmcnt(40)
    ds_write_b128 v10, v[64:67] offset:0
    ds_write_b128 v10, v[68:71] offset:1152
    ds_write_b128 v10, v[72:75] offset:2304
    ds_write_b128 v10, v[76:79] offset:3456
    ds_write_b128 v10, v[80:83] offset:4608
    ds_write_b128 v10, v[84:87] offset:5760
    ds_write_b128 v10, v[88:91] offset:6912
    ds_write_b128 v10, v[92:95] offset:8064
    ds_read_b64_tr_b16 v[64:65], v14 offset:0
    ds_read_b64_tr_b16 v[66:67], v14 offset:4608
    ds_read_b64_tr_b16 v[68:69], v14 offset:32
    ds_read_b64_tr_b16 v[70:71], v14 offset:4640
    ds_read_b64_tr_b16 v[72:73], v14 offset:64
    ds_read_b64_tr_b16 v[74:75], v14 offset:4672
    ds_read_b64_tr_b16 v[76:77], v14 offset:96
    ds_read_b64_tr_b16 v[78:79], v14 offset:4704
    ds_read_b64_tr_b16 v[80:81], v14 offset:128
    ds_read_b64_tr_b16 v[82:83], v14 offset:4736
    ds_read_b64_tr_b16 v[84:85], v14 offset:160
    ds_read_b64_tr_b16 v[86:87], v14 offset:4768
    ds_read_b64_tr_b16 v[88:89], v14 offset:192
    ds_read_b64_tr_b16 v[90:91], v14 offset:4800
    ds_read_b64_tr_b16 v[92:93], v14 offset:224
    ds_read_b64_tr_b16 v[94:95], v14 offset:4832
    s_waitcnt vmcnt(32)
    ds_write_b128 v10, v[96:99] offset:0
    ds_write_b128 v10, v[100:103] offset:1152
    ds_write_b128 v10, v[104:107] offset:2304
    ds_write_b128 v10, v[108:111] offset:3456
    ds_write_b128 v10, v[112:115] offset:4608
    ds_write_b128 v10, v[116:119] offset:5760
    ds_write_b128 v10, v[120:123] offset:6912
    ds_write_b128 v10, v[124:127] offset:8064
    ds_read_b64_tr_b16 v[96:97], v14 offset:0
    ds_read_b64_tr_b16 v[98:99], v14 offset:4608
    ds_read_b64_tr_b16 v[100:101], v14 offset:32
    ds_read_b64_tr_b16 v[102:103], v14 offset:4640
    ds_read_b64_tr_b16 v[104:105], v14 offset:64
    ds_read_b64_tr_b16 v[106:107], v14 offset:4672
    ds_read_b64_tr_b16 v[108:109], v14 offset:96
    ds_read_b64_tr_b16 v[110:111], v14 offset:4704
    ds_read_b64_tr_b16 v[112:113], v14 offset:128
    ds_read_b64_tr_b16 v[114:115], v14 offset:4736
    ds_read_b64_tr_b16 v[116:117], v14 offset:160
    ds_read_b64_tr_b16 v[118:119], v14 offset:4768
    ds_read_b64_tr_b16 v[120:121], v14 offset:192
    ds_read_b64_tr_b16 v[122:123], v14 offset:4800
    ds_read_b64_tr_b16 v[124:125], v14 offset:224
    ds_read_b64_tr_b16 v[126:127], v14 offset:4832
    s_waitcnt vmcnt(28)
    ds_write_b128 v11, v[128:131] offset:0
    ds_write_b128 v11, v[132:135] offset:1280
    ds_write_b128 v11, v[136:139] offset:2560
    ds_write_b128 v11, v[140:143] offset:3840
    ds_read_b64_tr_b16 v[128:129], v15 offset:0
    ds_read_b64_tr_b16 v[130:131], v15 offset:2560
    ds_read_b64_tr_b16 v[132:133], v15 offset:32
    ds_read_b64_tr_b16 v[134:135], v15 offset:2592
    ds_read_b64_tr_b16 v[136:137], v15 offset:64
    ds_read_b64_tr_b16 v[138:139], v15 offset:2624
    ds_read_b64_tr_b16 v[140:141], v15 offset:96
    ds_read_b64_tr_b16 v[142:143], v15 offset:2656
    s_waitcnt vmcnt(24)
    ds_write_b128 v11, v[144:147] offset:0
    ds_write_b128 v11, v[148:151] offset:1280
    ds_write_b128 v11, v[152:155] offset:2560
    ds_write_b128 v11, v[156:159] offset:3840
    ds_read_b64_tr_b16 v[144:145], v15 offset:0
    ds_read_b64_tr_b16 v[146:147], v15 offset:2560
    ds_read_b64_tr_b16 v[148:149], v15 offset:32
    ds_read_b64_tr_b16 v[150:151], v15 offset:2592
    ds_read_b64_tr_b16 v[152:153], v15 offset:64
    ds_read_b64_tr_b16 v[154:155], v15 offset:2624
    ds_read_b64_tr_b16 v[156:157], v15 offset:96
    ds_read_b64_tr_b16 v[158:159], v15 offset:2656
    s_waitcnt vmcnt(20)
    ds_write_b128 v11, v[160:163] offset:0
    ds_write_b128 v11, v[164:167] offset:1280
    ds_write_b128 v11, v[168:171] offset:2560
    ds_write_b128 v11, v[172:175] offset:3840
    ds_read_b64_tr_b16 v[160:161], v15 offset:0
    ds_read_b64_tr_b16 v[162:163], v15 offset:2560
    ds_read_b64_tr_b16 v[164:165], v15 offset:32
    ds_read_b64_tr_b16 v[166:167], v15 offset:2592
    ds_read_b64_tr_b16 v[168:169], v15 offset:64
    ds_read_b64_tr_b16 v[170:171], v15 offset:2624
    ds_read_b64_tr_b16 v[172:173], v15 offset:96
    ds_read_b64_tr_b16 v[174:175], v15 offset:2656
    s_waitcnt vmcnt(16)
    ds_write_b128 v11, v[176:179] offset:0
    ds_write_b128 v11, v[180:183] offset:1280
    ds_write_b128 v11, v[184:187] offset:2560
    ds_write_b128 v11, v[188:191] offset:3840
    ds_read_b64_tr_b16 v[176:177], v15 offset:0
    ds_read_b64_tr_b16 v[178:179], v15 offset:2560
    ds_read_b64_tr_b16 v[180:181], v15 offset:32
    ds_read_b64_tr_b16 v[182:183], v15 offset:2592
    ds_read_b64_tr_b16 v[184:185], v15 offset:64
    ds_read_b64_tr_b16 v[186:187], v15 offset:2624
    ds_read_b64_tr_b16 v[188:189], v15 offset:96
    ds_read_b64_tr_b16 v[190:191], v15 offset:2656
    s_waitcnt vmcnt(12)
    ds_write_b128 v11, v[192:195] offset:0
    ds_write_b128 v11, v[196:199] offset:1280
    ds_write_b128 v11, v[200:203] offset:2560
    ds_write_b128 v11, v[204:207] offset:3840
    ds_read_b64_tr_b16 v[192:193], v15 offset:0
    ds_read_b64_tr_b16 v[194:195], v15 offset:2560
    ds_read_b64_tr_b16 v[196:197], v15 offset:32
    ds_read_b64_tr_b16 v[198:199], v15 offset:2592
    ds_read_b64_tr_b16 v[200:201], v15 offset:64
    ds_read_b64_tr_b16 v[202:203], v15 offset:2624
    ds_read_b64_tr_b16 v[204:205], v15 offset:96
    ds_read_b64_tr_b16 v[206:207], v15 offset:2656
    s_waitcnt vmcnt(8)
    ds_write_b128 v11, v[208:211] offset:0
    ds_write_b128 v11, v[212:215] offset:1280
    ds_write_b128 v11, v[216:219] offset:2560
    ds_write_b128 v11, v[220:223] offset:3840
    ds_read_b64_tr_b16 v[208:209], v15 offset:0
    ds_read_b64_tr_b16 v[210:211], v15 offset:2560
    ds_read_b64_tr_b16 v[212:213], v15 offset:32
    ds_read_b64_tr_b16 v[214:215], v15 offset:2592
    ds_read_b64_tr_b16 v[216:217], v15 offset:64
    ds_read_b64_tr_b16 v[218:219], v15 offset:2624
    ds_read_b64_tr_b16 v[220:221], v15 offset:96
    ds_read_b64_tr_b16 v[222:223], v15 offset:2656
    s_waitcnt vmcnt(4)
    ds_write_b128 v11, v[224:227] offset:0
    ds_write_b128 v11, v[228:231] offset:1280
    ds_write_b128 v11, v[232:235] offset:2560
    ds_write_b128 v11, v[236:239] offset:3840
    ds_read_b64_tr_b16 v[224:225], v15 offset:0
    ds_read_b64_tr_b16 v[226:227], v15 offset:2560
    ds_read_b64_tr_b16 v[228:229], v15 offset:32
    ds_read_b64_tr_b16 v[230:231], v15 offset:2592
    ds_read_b64_tr_b16 v[232:233], v15 offset:64
    ds_read_b64_tr_b16 v[234:235], v15 offset:2624
    ds_read_b64_tr_b16 v[236:237], v15 offset:96
    ds_read_b64_tr_b16 v[238:239], v15 offset:2656
    s_waitcnt vmcnt(0)
    ds_write_b128 v11, v[240:243] offset:0
    ds_write_b128 v11, v[244:247] offset:1280
    ds_write_b128 v11, v[248:251] offset:2560
    ds_write_b128 v11, v[252:255] offset:3840
    ds_read_b64_tr_b16 v[240:241], v15 offset:0
    ds_read_b64_tr_b16 v[242:243], v15 offset:2560
    ds_read_b64_tr_b16 v[244:245], v15 offset:32
    ds_read_b64_tr_b16 v[246:247], v15 offset:2592
    ds_read_b64_tr_b16 v[248:249], v15 offset:64
    ds_read_b64_tr_b16 v[250:251], v15 offset:2624
    ds_read_b64_tr_b16 v[252:253], v15 offset:96
    ds_read_b64_tr_b16 v[254:255], v15 offset:2656
L_noffn1:
    s_waitcnt vmcnt(0)
L_noffn:
    s_waitcnt lgkmcnt(0)
    s_mov_b32 s3, 0
    s_cmp_lg_u32 s64, 0
    s_cbranch_scc1 L_noarr
    v_add_u32 v8, 5, v1
    v_lshlrev_b32 v9, 9, v8
    v_lshlrev_b32 v8, 15, v8
    s_lshl_b32 s52, s45, 21
    v_add_u32 v8, s52, v8
    v_add_u32 v9, 0, v9
    v_mov_b32 v10, s45
    s_or_b32 s52, s45, 0x200
    v_mov_b32 v11, s52
    v_cmp_eq_u32 vcc, 63, v1
    s_nop 1
    v_cndmask_b32 v10, v10, v11, vcc
    v_mov_b32 v11, 0
    v_cmp_gt_u32 vcc, 19, v1
    s_nop 1
    v_cndmask_b32 v8, -2, v8, vcc
    v_add_u32 v12, 93952, v2
    ds_write_b128 v12, v[8:11]
    v_mov_b32 v17, 0
    s_mov_b32 s65, 0
L_arr:
    s_sleep 127
    global_load_dword v24, v17, s[24:25] sc1
    s_waitcnt vmcnt(0)
    v_readfirstlane_b32 s52, v24
    s_add_u32 s65, s65, 1
    s_cmp_gt_u32 s65, 40000
    s_cbranch_scc1 L_noarr
    s_cmp_lt_u32 s52, 256
    s_cbranch_scc1 L_arr
    v_and_b32 v8, 7, v1
    v_lshlrev_b32 v8, 2, v8
    s_lshl_b32 s52, s48, 5
    s_add_u32 s52, s52, 132096
    buffer_load_dword v9, v8, s[36:39], s52 offen sc1
    s_waitcnt vmcnt(0)
    v_readfirstlane_b32 s53, v9
    s_nop 1
    v_cmp_ne_u32 vcc, s53, v9
    s_nop 0
    s_cmp_eq_u64 vcc, 0
    s_cselect_b32 s3, 1, 0
L_noarr:
    s_waitcnt lgkmcnt(0)
    s_barrier
    v_lshlrev_b32 v16, 5, v0
    v_mov_b32 v17, 0
    ds_read_b128 v[8:11], v16 offset:0
    ds_read_b128 v[12:15], v16 offset:16
    ds_read_b128 v[20:23], v17 offset:24576
    s_waitcnt lgkmcnt(0)
    v_max_f32 v20, v20, v21
    v_max3_f32 v20, v20, v22, v23
    v_sub_f32 v8, v8, v20
    v_sub_f32 v9, v9, v20
    v_sub_f32 v10, v10, v20
    v_sub_f32 v11, v11, v20
    v_sub_f32 v12, v12, v20
    v_sub_f32 v13, v13, v20
    v_sub_f32 v14, v14, v20
    v_sub_f32 v15, v15, v20
    v_mul_f32 v8, s60, v8
    v_mul_f32 v9, s60, v9
    v_mul_f32 v10, s60, v10
    v_mul_f32 v11, s60, v11
    v_mul_f32 v12, s60, v12
    v_mul_f32 v13, s60, v13
    v_mul_f32 v14, s60, v14
    v_mul_f32 v15, s60, v15
    v_exp_f32 v8, v8
    v_exp_f32 v9, v9
    v_exp_f32 v10, v10
    v_exp_f32 v11, v11
    v_exp_f32 v12, v12
    v_exp_f32 v13, v13
    v_exp_f32 v14, v14
    v_exp_f32 v15, v15
    v_add_f32 v18, v8, v9
    v_add_f32 v18, v18, v10
    v_add_f32 v18, v18, v11
    v_add_f32 v18, v18, v12
    v_add_f32 v18, v18, v13
    v_add_f32 v18, v18, v14
    v_add_f32 v18, v18, v15
    s_nop 1
    v_add_f32_dpp v18, v18, v18 row_ror:8 row_mask:0xf bank_mask:0xf
    s_nop 1
    v_add_f32_dpp v18, v18, v18 row_ror:4 row_mask:0xf bank_mask:0xf
    s_nop 1
    v_add_f32_dpp v18, v18, v18 row_ror:2 row_mask:0xf bank_mask:0xf
    s_nop 1
    v_add_f32_dpp v18, v18, v18 row_ror:1 row_mask:0xf bank_mask:0xf
    v_mov_b32 v19, v18
    s_nop 1
    v_permlane16_swap_b32 v18, v19
    v_add_f32 v18, v18, v19
    v_mov_b32 v19, v18
    s_nop 1
    v_permlane32_swap_b32 v18, v19
    v_add_f32 v18, v18, v19
    s_lshl_b32 s52, s44, 2
    v_mov_b32 v19, s52
    ds_write_b32 v19, v18 offset:24608
    s_waitcnt lgkmcnt(0)
    s_barrier
    s_cmp_lg_u32 s64, 0
    s_cbranch_scc1 L_noex
    s_memrealtime s[98:99]
    ds_read_b128 v[24:27], v17 offset:24608
    ds_read_b128 v[28:31], v17 offset:24624
    s_waitcnt lgkmcnt(0)
    v_add_f32 v24, v24, v25
    v_add_f32 v26, v26, v27
    v_add_f32 v28, v28, v29
    v_add_f32 v30, v30, v31
    v_add_f32 v24, v24, v26
    v_add_f32 v28, v28, v30
    v_add_f32 v21, v24, v28
    s_mov_b64 exec, 1
    s_lshl_b32 s52, s2, 7
    s_add_u32 s52, s52, 0
    s_cmp_eq_u32 s3, 1
    s_cbranch_scc1 L_ls1
    buffer_store_dwordx2 v[20:21], v17, s[36:39], s52 offen sc1
    s_branch L_le1
L_ls1:
    s_nop 3
    buffer_store_dwordx2 v[20:21], v17, s[36:39], s52 offen
L_le1:
    s_mov_b64 exec, -1
    s_mov_b64 exec, 1
    s_and_b32 s54, s98, 0x7fffffff
    v_mov_b32 v30, 0
    v_mov_b32 v24, s54
    s_lshl_b32 s52, s46, 7
    s_lshl_b32 s53, s45, 2
    s_add_u32 s52, s52, s53
    s_add_u32 s52, s52, 163840
    buffer_store_dword v24, v30, s[36:39], s52 offen sc1
    s_mov_b64 exec, -1
    s_xor_b32 s53, s2, 8
    s_lshl_b32 s53, s53, 7
    s_add_u32 s53, s53, 0
    s_mov_b32 s65, 0
L_poll2_ml:
    buffer_load_dwordx2 v[24:25], v17, s[36:39], s53 offen sc1
    s_waitcnt vmcnt(0)
    v_cmp_eq_u32 vcc, -1, v24
    v_cmp_eq_u32 s[54:55], -1, v25
    s_nop 0
    s_or_b64 vcc, vcc, s[54:55]
    s_add_u32 s65, s65, 1
    s_cmp_gt_u32 s65, 40000
    s_cbranch_scc1 L_poll2_ml_x
    s_cmp_lg_u64 vcc, 0
    s_cbranch_scc1 L_poll2_ml
L_poll2_ml_x:
    v_max_f32 v26, v20, v24
    v_sub_f32 v27, v20, v26
    v_sub_f32 v28, v24, v26
    v_mul_f32 v27, s60, v27
    v_mul_f32 v28, s60, v28
    v_exp_f32 v27, v27
    v_exp_f32 v28, v28
    v_mul_f32 v29, v21, v27
    v_mul_f32 v30, v25, v28
    v_add_f32 v29, v29, v30
    v_rcp_f32 v30, v29
    s_nop 0
    v_mul_f32 v31, v27, v30
    v_fma_f32 v24, -v31, v29, v27
    v_fma_f32 v31, v24, v30, v31
    ds_write_b32 v17, v31 offset:24640
    s_waitcnt lgkmcnt(0)
L_noex:
    s_barrier
    ds_read_b32 v18, v17 offset:24640
    s_waitcnt lgkmcnt(0)
    v_mul_f32 v8, v8, v18
    v_mul_f32 v9, v9, v18
    v_mul_f32 v10, v10, v18
    v_mul_f32 v11, v11, v18
    v_mul_f32 v12, v12, v18
    v_mul_f32 v13, v13, v18
    v_mul_f32 v14, v14, v18
    v_mul_f32 v15, v15, v18
    v_cvt_pk_bf16_f32 v19, v8, v9
    v_lshlrev_b32 v8, 16, v19
    v_and_b32 v9, s61, v19
    v_cvt_pk_bf16_f32 v19, v10, v11
    v_lshlrev_b32 v10, 16, v19
    v_and_b32 v11, s61, v19
    v_cvt_pk_bf16_f32 v19, v12, v13
    v_lshlrev_b32 v12, 16, v19
    v_and_b32 v13, s61, v19
    v_cvt_pk_bf16_f32 v19, v14, v15
    v_lshlrev_b32 v14, 16, v19
    v_and_b32 v15, s61, v19
    ds_write_b128 v16, v[8:11] offset:0
    ds_write_b128 v16, v[12:15] offset:16
    s_waitcnt lgkmcnt(0)
    s_barrier
    s_mov_b32 s70, 0
    s_cmp_lg_u32 s45, 0
    s_cbranch_scc1 L_noloc
    v_and_b32 v8, 31, v1
    v_lshlrev_b32 v8, 2, v8
    s_mov_b32 s52, 131072
    buffer_load_dword v9, v8, s[36:39], s52 offen sc1
    s_waitcnt vmcnt(0)
    v_readfirstlane_b32 s53, v9
    s_nop 1
    v_cmp_ne_u32 vcc, s53, v9
    s_nop 0
    s_cmp_eq_u64 vcc, 0
    s_cselect_b32 s70, 1, 0
L_noloc:
    s_cmp_lg_u32 s64, 0
    s_cbranch_scc1 L_noplan
    v_and_b32 v8, 7, v1
    v_lshlrev_b32 v9, 2, v8
    s_lshl_b32 s52, s46, 7
    s_add_u32 s52, s52, 163840
    s_mov_b32 s65, 0
L_poll3_tm:
    s_sleep 8
    buffer_load_dword v10, v9, s[36:39], s52 offen sc1
    s_waitcnt vmcnt(0)
    v_cmp_eq_u32 vcc, -1, v10
    s_add_u32 s65, s65, 1
    s_cmp_gt_u32 s65, 40000
    s_cbranch_scc1 L_poll3_tm_x
    s_cmp_lg_u64 vcc, 0
    s_cbranch_scc1 L_poll3_tm
L_poll3_tm_x:
    v_readfirstlane_b32 s52, v10
    s_nop 1
    v_subrev_u32 v10, s52, v10
    v_lshlrev_b32 v10, 1, v10
    v_ashrrev_i32 v10, 1, v10
    v_cvt_f32_i32 v10, v10
    s_nop 1
    v_add_f32_dpp v11, v10, v10 row_ror:1 row_mask:0xf bank_mask:0xf
    s_nop 1
    v_add_f32_dpp v11, v11, v11 row_ror:2 row_mask:0xf bank_mask:0xf
    s_nop 1
    v_add_f32_dpp v11, v11, v11 row_ror:4 row_mask:0xf bank_mask:0xf
    s_nop 0
    v_readfirstlane_b32 s52, v11
    s_nop 1
    v_mov_b32 v11, s52
    s_mov_b32 s53, 0xbe000000
    v_fma_f32 v10, v11, s53, v10
    v_mul_f32 v10, 0x3c14f209, v10
    v_rndne_f32 v10, v10
    v_cvt_i32_f32 v10, v10
    v_max_i32 v11, 0, v10
    v_min_i32 v11, 5, v11
    v_sub_u32 v12, 0, v10
    v_max_i32 v12, 0, v12
    v_min_i32 v12, 5, v12
    v_cmp_gt_u32 vcc, 8, v1
    s_nop 1
    v_cndmask_b32 v11, 0, v11, vcc
    v_cndmask_b32 v12, 0, v12, vcc
    v_mov_b32 v13, v11
    v_mov_b32 v14, v12
    s_nop 0
    v_add_u32_dpp v13, v13, v13 row_shr:1 row_mask:0xf bank_mask:0xf bound_ctrl:0
    v_add_u32_dpp v14, v14, v14 row_shr:1 row_mask:0xf bank_mask:0xf bound_ctrl:0
    s_nop 0
    v_add_u32_dpp v13, v13, v13 row_shr:2 row_mask:0xf bank_mask:0xf bound_ctrl:0
    v_add_u32_dpp v14, v14, v14 row_shr:2 row_mask:0xf bank_mask:0xf bound_ctrl:0
    s_nop 0
    v_add_u32_dpp v13, v13, v13 row_shr:4 row_mask:0xf bank_mask:0xf bound_ctrl:0
    v_add_u32_dpp v14, v14, v14 row_shr:4 row_mask:0xf bank_mask:0xf bound_ctrl:0
    v_readlane_b32 s52, v13, 7
    v_readlane_b32 s53, v14, 7
    v_sub_u32 v13, v13, v11
    v_sub_u32 v14, v14, v12
    s_min_u32 s52, s52, s53
    v_sub_u32 v15, s52, v13
    v_max_i32 v15, 0, v15
    v_min_i32 v11, v11, v15
    v_sub_u32 v15, s52, v14
    v_max_i32 v15, 0, v15
    v_min_i32 v12, v12, v15
    v_add_u32 v16, v13, v11
    v_add_u32 v17, v14, v12
    v_readlane_b32 s66, v13, s45
    v_readlane_b32 s67, v11, s45
    v_readlane_b32 s68, v14, s45
    v_readlane_b32 s69, v12, s45
    v_mov_b32 v30, 0
    v_mov_b32 v31, 94256
    s_mov_b32 s101, 0
    s_cmp_eq_u32 s67, 0
    s_cbranch_scc1 L_nodon
    s_lshl_b32 s52, s2, 12
    s_add_u32 s52, s52, 2097152
    ds_read_b128 v[32:35], v2 offset:15360
    ds_read_b128 v[36:39], v2 offset:14336
    ds_read_b128 v[40:43], v2 offset:13312
    s_waitcnt lgkmcnt(0)
    buffer_store_dwordx4 v[32:35], v2, s[36:39], s52 offen offset:3072 sc1
    s_cmp_le_u32 s67, 2
    s_cbranch_scc1 L_donx
    buffer_store_dwordx4 v[36:39], v2, s[36:39], s52 offen offset:2048 sc1
    s_cmp_le_u32 s67, 4
    s_cbranch_scc1 L_donx
    buffer_store_dwordx4 v[40:43], v2, s[36:39], s52 offen offset:1024 sc1
L_donx:
    s_mov_b64 exec, 1
    s_lshl_b32 s52, s2, 7
    s_add_u32 s52, s52, 65552
    s_waitcnt vmcnt(0)
    buffer_store_dword v30, v30, s[36:39], s52 offen sc1
    s_mov_b64 exec, -1
L_nodon:
    v_and_b32 v18, 31, v1
    v_lshlrev_b32 v18, 4, v18
    v_lshlrev_b32 v25, 9, v1
    v_add_u32 v25, 94976, v25
    v_mov_b32 v24, 0
    v_mov_b32 v26, 0
    v_mov_b32 v27, 0
    s_cmp_eq_u32 s69, 0
    s_cbranch_scc1 L_rcvx
    s_add_u32 s58, s68, 0
    v_cmp_ge_u32 vcc, s58, v13
    v_cmp_lt_u32 s[54:55], s58, v16
    s_nop 0
    s_and_b64 vcc, vcc, s[54:55]
    s_and_b32 s52, vcc_lo, 0xff
    s_ff1_i32_b32 s100, s52
    s_and_b32 s100, s100, 7
    v_readlane_b32 s52, v13, s100
    s_nop 0
    s_sub_u32 s58, s58, s52
    s_sub_u32 s58, 31, s58
    s_lshl_b32 s52, s46, 3
    s_add_u32 s71, s52, s100
    s_bitcmp1_b32 s101, s100
    s_cbranch_scc1 L_nopf0
    s_bitset1_b32 s101, s100
    s_lshl_b32 s52, s71, 7
    s_add_u32 s52, s52, 65552
    s_mov_b32 s65, 0
L_pf0:
    buffer_load_dword v19, v30, s[36:39], s52 offen sc1
    s_waitcnt vmcnt(0)
    v_readfirstlane_b32 s53, v19
    s_add_u32 s65, s65, 1
    s_cmp_gt_u32 s65, 40000
    s_cbranch_scc1 L_nopf0
    s_cmp_eq_u32 s53, -1
    s_cbranch_scc1 L_pf0
L_nopf0:
    s_lshl_b32 s53, s71, 12
    s_lshl_b32 s52, s58, 9
    s_add_u32 s53, s53, s52
    s_add_u32 s53, s53, 2084864
    buffer_load_dwordx4 v[32:35], v18, s[36:39], s53 offen sc1
    s_lshl_b32 s58, s58, 15
    s_lshl_b32 s52, s100, 21
    s_add_u32 s58, s58, s52
    v_writelane_b32 v24, s58, 0
    v_writelane_b32 v26, s100, 0
    s_cmp_le_u32 s69, 1
    s_cbranch_scc1 L_rcvy
    s_add_u32 s58, s68, 1
    v_cmp_ge_u32 vcc, s58, v13
    v_cmp_lt_u32 s[54:55], s58, v16
    s_nop 0
    s_and_b64 vcc, vcc, s[54:55]
    s_and_b32 s52, vcc_lo, 0xff
    s_ff1_i32_b32 s100, s52
    s_and_b32 s100, s100, 7
    v_readlane_b32 s52, v13, s100
    s_nop 0
    s_sub_u32 s58, s58, s52
    s_sub_u32 s58, 31, s58
    s_lshl_b32 s52, s46, 3
    s_add_u32 s71, s52, s100
    s_bitcmp1_b32 s101, s100
    s_cbranch_scc1 L_nopf1
    s_bitset1_b32 s101, s100
    s_lshl_b32 s52, s71, 7
    s_add_u32 s52, s52, 65552
    s_mov_b32 s65, 0
L_pf1:
    buffer_load_dword v19, v30, s[36:39], s52 offen sc1
    s_waitcnt vmcnt(0)
    v_readfirstlane_b32 s53, v19
    s_add_u32 s65, s65, 1
    s_cmp_gt_u32 s65, 40000
    s_cbranch_scc1 L_nopf1
    s_cmp_eq_u32 s53, -1
    s_cbranch_scc1 L_pf1
L_nopf1:
    s_lshl_b32 s53, s71, 12
    s_lshl_b32 s52, s58, 9
    s_add_u32 s53, s53, s52
    s_add_u32 s53, s53, 2084864
    buffer_load_dwordx4 v[36:39], v18, s[36:39], s53 offen sc1
    s_lshl_b32 s58, s58, 15
    s_lshl_b32 s52, s100, 21
    s_add_u32 s58, s58, s52
    v_writelane_b32 v24, s58, 1
    v_writelane_b32 v26, s100, 1
    s_cmp_le_u32 s69, 2
    s_cbranch_scc1 L_rcvy
    s_add_u32 s58, s68, 2
    v_cmp_ge_u32 vcc, s58, v13
    v_cmp_lt_u32 s[54:55], s58, v16
    s_nop 0
    s_and_b64 vcc, vcc, s[54:55]
    s_and_b32 s52, vcc_lo, 0xff
    s_ff1_i32_b32 s100, s52
    s_and_b32 s100, s100, 7
    v_readlane_b32 s52, v13, s100
    s_nop 0
    s_sub_u32 s58, s58, s52
    s_sub_u32 s58, 31, s58
    s_lshl_b32 s52, s46, 3
    s_add_u32 s71, s52, s100
    s_bitcmp1_b32 s101, s100
    s_cbranch_scc1 L_nopf2
    s_bitset1_b32 s101, s100
    s_lshl_b32 s52, s71, 7
    s_add_u32 s52, s52, 65552
    s_mov_b32 s65, 0
L_pf2:
    buffer_load_dword v19, v30, s[36:39], s52 offen sc1
    s_waitcnt vmcnt(0)
    v_readfirstlane_b32 s53, v19
    s_add_u32 s65, s65, 1
    s_cmp_gt_u32 s65, 40000
    s_cbranch_scc1 L_nopf2
    s_cmp_eq_u32 s53, -1
    s_cbranch_scc1 L_pf2
L_nopf2:
    s_lshl_b32 s53, s71, 12
    s_lshl_b32 s52, s58, 9
    s_add_u32 s53, s53, s52
    s_add_u32 s53, s53, 2084864
    buffer_load_dwordx4 v[40:43], v18, s[36:39], s53 offen sc1
    s_lshl_b32 s58, s58, 15
    s_lshl_b32 s52, s100, 21
    s_add_u32 s58, s58, s52
    v_writelane_b32 v24, s58, 2
    v_writelane_b32 v26, s100, 2
    s_cmp_le_u32 s69, 3
    s_cbranch_scc1 L_rcvy
    s_add_u32 s58, s68, 3
    v_cmp_ge_u32 vcc, s58, v13
    v_cmp_lt_u32 s[54:55], s58, v16
    s_nop 0
    s_and_b64 vcc, vcc, s[54:55]
    s_and_b32 s52, vcc_lo, 0xff
    s_ff1_i32_b32 s100, s52
    s_and_b32 s100, s100, 7
    v_readlane_b32 s52, v13, s100
    s_nop 0
    s_sub_u32 s58, s58, s52
    s_sub_u32 s58, 31, s58
    s_lshl_b32 s52, s46, 3
    s_add_u32 s71, s52, s100
    s_bitcmp1_b32 s101, s100
    s_cbranch_scc1 L_nopf3
    s_bitset1_b32 s101, s100
    s_lshl_b32 s52, s71, 7
    s_add_u32 s52, s52, 65552
    s_mov_b32 s65, 0
L_pf3:
    buffer_load_dword v19, v30, s[36:39], s52 offen sc1
    s_waitcnt vmcnt(0)
    v_readfirstlane_b32 s53, v19
    s_add_u32 s65, s65, 1
    s_cmp_gt_u32 s65, 40000
    s_cbranch_scc1 L_nopf3
    s_cmp_eq_u32 s53, -1
    s_cbranch_scc1 L_pf3
L_nopf3:
    s_lshl_b32 s53, s71, 12
    s_lshl_b32 s52, s58, 9
    s_add_u32 s53, s53, s52
    s_add_u32 s53, s53, 2084864
    buffer_load_dwordx4 v[44:47], v18, s[36:39], s53 offen sc1
    s_lshl_b32 s58, s58, 15
    s_lshl_b32 s52, s100, 21
    s_add_u32 s58, s58, s52
    v_writelane_b32 v24, s58, 3
    v_writelane_b32 v26, s100, 3
    s_cmp_le_u32 s69, 4
    s_cbranch_scc1 L_rcvy
    s_add_u32 s58, s68, 4
    v_cmp_ge_u32 vcc, s58, v13
    v_cmp_lt_u32 s[54:55], s58, v16
    s_nop 0
    s_and_b64 vcc, vcc, s[54:55]
    s_and_b32 s52, vcc_lo, 0xff
    s_ff1_i32_b32 s100, s52
    s_and_b32 s100, s100, 7
    v_readlane_b32 s52, v13, s100
    s_nop 0
    s_sub_u32 s58, s58, s52
    s_sub_u32 s58, 31, s58
    s_lshl_b32 s52, s46, 3
    s_add_u32 s71, s52, s100
    s_bitcmp1_b32 s101, s100
    s_cbranch_scc1 L_nopf4
    s_bitset1_b32 s101, s100
    s_lshl_b32 s52, s71, 7
    s_add_u32 s52, s52, 65552
    s_mov_b32 s65, 0
L_pf4:
    buffer_load_dword v19, v30, s[36:39], s52 offen sc1
    s_waitcnt vmcnt(0)
    v_readfirstlane_b32 s53, v19
    s_add_u32 s65, s65, 1
    s_cmp_gt_u32 s65, 40000
    s_cbranch_scc1 L_nopf4
    s_cmp_eq_u32 s53, -1
    s_cbranch_scc1 L_pf4
L_nopf4:
    s_lshl_b32 s53, s71, 12
    s_lshl_b32 s52, s58, 9
    s_add_u32 s53, s53, s52
    s_add_u32 s53, s53, 2084864
    buffer_load_dwordx4 v[48:51], v18, s[36:39], s53 offen sc1
    s_lshl_b32 s58, s58, 15
    s_lshl_b32 s52, s100, 21
    s_add_u32 s58, s58, s52
    v_writelane_b32 v24, s58, 4
    v_writelane_b32 v26, s100, 4
L_rcvy:
    v_add_u32 v19, 94976, v18
    s_waitcnt vmcnt(0)
    ds_write_b128 v19, v[32:35] offset:0
    ds_write_b128 v19, v[36:39] offset:512
    ds_write_b128 v19, v[40:43] offset:1024
    ds_write_b128 v19, v[44:47] offset:1536
    ds_write_b128 v19, v[48:51] offset:2048
    v_add_u32 v19, v31, v2
    s_lshl_b32 s52, 1, s69
    s_sub_u32 s52, s52, 1
    s_mov_b32 exec_lo, s52
    s_mov_b32 exec_hi, 0
    ds_write_b128 v19, v[24:27]
    s_mov_b64 exec, -1
    s_lshl_b32 s52, s69, 4
    v_add_u32 v31, s52, v31
L_rcvx:
    v_add_u32 v24, 24, v1
    v_lshlrev_b32 v25, 9, v24
    v_lshlrev_b32 v24, 15, v24
    s_lshl_b32 s52, s45, 21
    v_add_u32 v24, s52, v24
    v_add_u32 v25, 0, v25
    s_or_b32 s53, s45, 0x100
    v_mov_b32 v26, s45
    v_mov_b32 v28, s53
    v_cmp_eq_u32 vcc, 0, v1
    s_nop 1
    v_cndmask_b32 v26, v26, v28, vcc
    s_cmp_eq_u32 s69, 0
    s_cbranch_scc0 L_keepflag
    v_mov_b32 v26, s45
L_keepflag:
    v_mov_b32 v27, 0
    s_sub_u32 s52, 8, s67
    v_cmp_gt_u32 vcc, s52, v1
    s_nop 1
    v_cndmask_b32 v24, -1, v24, vcc
    v_add_u32 v19, v31, v2
    s_mov_b64 exec, 0x1ff
    ds_write_b128 v19, v[24:27]
    s_mov_b64 exec, -1
    s_cmp_eq_u32 s69, 0
    s_cbranch_scc1 L_nosend
    s_mov_b32 s65, 0
L_wsig:
    s_sleep 4
    ds_read_b32 v19, v30 offset:24708
    s_waitcnt lgkmcnt(0)
    v_readfirstlane_b32 s52, v19
    s_add_u32 s65, s65, 1
    s_cmp_gt_u32 s65, 800000
    s_cbranch_scc1 L_snd
    s_cmp_lt_u32 s52, 4
    s_cbranch_scc1 L_wsig
L_snd:
    s_ff1_i32_b32 s100, s101
    s_lshl_b32 s52, 1, s100
    s_xor_b32 s101, s101, s52
    s_lshl_b32 s52, s100, 9
    v_add_u32 v19, s52, v18
    ds_read_b128 v[20:23], v19 offset:20480
    s_lshl_b32 s52, s46, 3
    s_add_u32 s52, s52, s100
    s_lshl_b32 s52, s52, 12
    s_lshl_b32 s53, s45, 9
    s_add_u32 s52, s52, s53
    s_add_u32 s52, s52, 524288
    s_mov_b32 exec_hi, 0
    s_waitcnt lgkmcnt(0)
    buffer_store_dwordx4 v[20:23], v18, s[36:39], s52 offen sc1
    s_lshl_b32 s52, s46, 3
    s_add_u32 s52, s52, s100
    s_lshl_b32 s52, s52, 7
    s_lshl_b32 s53, s45, 2
    s_add_u32 s52, s52, s53
    s_add_u32 s52, s52, 65568
    s_mov_b64 exec, 1
    s_waitcnt vmcnt(0)
    buffer_store_dword v30, v30, s[36:39], s52 offen sc1
    s_mov_b64 exec, -1
    s_cmp_lg_u32 s101, 0
    s_cbranch_scc1 L_snd
L_nosend:
    s_cmp_eq_u32 s67, 0
    s_cbranch_scc1 L_noplan
    s_add_u32 s52, s66, s67
    v_cmp_gt_u32 vcc, s52, v14
    v_cmp_lt_u32 s[54:55], s66, v17
    s_nop 0
    s_and_b64 vcc, vcc, s[54:55]
    v_cmp_lt_u32 s[54:55], 0, v12
    s_nop 0
    s_and_b64 vcc, vcc, s[54:55]
    s_and_b32 s101, vcc_lo, 0xff
    s_lshl_b32 s52, s45, 9
    v_add_u32 v29, s52, v18
L_col:
    s_ff1_i32_b32 s100, s101
    s_lshl_b32 s52, 1, s100
    s_xor_b32 s101, s101, s52
    s_lshl_b32 s52, s2, 7
    s_lshl_b32 s53, s100, 2
    s_add_u32 s52, s52, s53
    s_add_u32 s52, s52, 65568
    s_mov_b32 s65, 0
L_poll4_in:
    s_sleep 8
    buffer_load_dword v19, v30, s[36:39], s52 offen sc1
    s_waitcnt vmcnt(0)
    v_cmp_eq_u32 vcc, -1, v19
    s_add_u32 s65, s65, 1
    s_cmp_gt_u32 s65, 40000
    s_cbranch_scc1 L_poll4_in_x
    s_cmp_lg_u64 vcc, 0
    s_cbranch_scc1 L_poll4_in
L_poll4_in_x:
    s_lshl_b32 s52, s2, 12
    s_lshl_b32 s53, s100, 9
    s_add_u32 s52, s52, s53
    s_add_u32 s52, s52, 524288
    buffer_load_dwordx4 v[20:23], v18, s[36:39], s52 offen sc1
    s_waitcnt vmcnt(0)
    s_mov_b32 exec_hi, 0
    ds_add_f32 v29, v20 offset:20480
    ds_add_f32 v29, v21 offset:20484
    ds_add_f32 v29, v22 offset:20488
    ds_add_f32 v29, v23 offset:20492
    s_mov_b64 exec, -1
    s_cmp_lg_u32 s101, 0
    s_waitcnt lgkmcnt(0)
    s_cbranch_scc1 L_col
L_noplan:
    s_waitcnt lgkmcnt(0)
    v_lshrrev_b32 v8, 2, v6
    v_lshl_add_u32 v8, v5, 2, v8
    v_mul_u32_u24 v8, 160, v8
    v_and_b32 v9, 3, v6
    v_lshl_add_u32 v8, v9, 3, v8
    s_lshl_b32 s52, s64, 5
    s_add_u32 s52, s52, 36608
    v_add_u32 v8, s52, v8
    ds_read_b64_tr_b16 v[40:41], v8 offset:0
    ds_read_b64_tr_b16 v[42:43], v8 offset:2560
    ds_read_b64_tr_b16 v[44:45], v8 offset:5120
    ds_read_b64_tr_b16 v[46:47], v8 offset:7680
    ds_read_b64_tr_b16 v[48:49], v8 offset:10240
    ds_read_b64_tr_b16 v[50:51], v8 offset:12800
    ds_read_b64_tr_b16 v[52:53], v8 offset:15360
    ds_read_b64_tr_b16 v[54:55], v8 offset:17920
    v_lshrrev_b32 v10, 5, v1
    v_and_b32 v11, 31, v1
    v_lshlrev_b32 v36, 12, v10
    v_lshl_add_u32 v36, v11, 4, v36
    s_mul_i32 s52, s64, 272
    v_lshlrev_b32 v37, 3, v11
    v_add_u32 v37, s52, v37
    v_mul_u32_u24 v38, 272, v9
    v_lshl_add_u32 v38, v5, 3, v38
    v_add_u32 v38, 26880, v38
    s_lshl_b32 s52, s45, 9
    v_lshl_add_u32 v39, v11, 4, s52
    v_lshlrev_b32 v35, 4, v6
    s_lshl_b32 s56, s45, 9
    s_lshl_b32 s52, s47, 15
    s_add_u32 s56, s56, s52
    s_lshl_b32 s52, s64, 13
    s_add_u32 s56, s56, s52
    s_add_u32 s56, s56, 3145728
    s_lshl_b32 s57, s48, 13
    s_and_b32 s52, s46, 7
    s_lshl_b32 s52, s52, 10
    s_add_u32 s57, s57, s52
    s_lshl_b32 s52, s64, 8
    s_add_u32 s57, s57, s52
    s_add_u32 s57, s57, 196608
    s_waitcnt lgkmcnt(0)
    s_barrier
    s_cmp_lg_u32 s64, 0
    s_cbranch_scc1 L_nopub
    ds_read_b128 v[8:11], v39 offset:20480
    s_mov_b32 exec_hi, 0
    s_lshl_b32 s52, s2, 9
    s_add_u32 s52, s52, 3145728
    s_waitcnt lgkmcnt(0)
    s_cmp_eq_u32 s3, 1
    s_cbranch_scc1 L_ls5
    buffer_store_dwordx4 v[8:11], v2, s[36:39], s52 offen sc1
    s_branch L_le5
L_ls5:
    s_nop 3
    buffer_store_dwordx4 v[8:11], v2, s[36:39], s52 offen
L_le5:
    s_mov_b64 exec, -1
L_nopub:
    s_mov_b32 s65, 0
L_poll6_o:
    buffer_load_dwordx4 v[16:19], v36, s[36:39], s56 offen sc1
    s_waitcnt vmcnt(0)
    v_cmp_eq_u32 vcc, -1, v16
    v_cmp_eq_u32 s[54:55], -1, v17
    s_nop 0
    s_or_b64 vcc, vcc, s[54:55]
    v_cmp_eq_u32 s[54:55], -1, v18
    s_nop 0
    s_or_b64 vcc, vcc, s[54:55]
    v_cmp_eq_u32 s[54:55], -1, v19
    s_nop 0
    s_or_b64 vcc, vcc, s[54:55]
    s_add_u32 s65, s65, 1
    s_cmp_gt_u32 s65, 40000
    s_cbranch_scc1 L_poll6_o_x
    s_cmp_lg_u64 vcc, 0
    s_cbranch_scc1 L_poll6_o
L_poll6_o_x:
    v_mov_b32 v20, v16
    v_mov_b32 v21, v17
    v_mov_b32 v22, v18
    v_mov_b32 v23, v19
    v_permlane32_swap_b32 v16, v20
    v_permlane32_swap_b32 v17, v21
    v_permlane32_swap_b32 v18, v22
    v_permlane32_swap_b32 v19, v23
    v_add_f32 v16, v16, v20
    v_add_f32 v17, v17, v21
    v_add_f32 v18, v18, v22
    v_add_f32 v19, v19, v23
    v_cvt_pk_bf16_f32 v16, v16, v17
    v_cvt_pk_bf16_f32 v17, v18, v19
    ds_write_b64 v37, v[16:17] offset:26880
    s_waitcnt lgkmcnt(0)
    s_barrier
    ds_read2_b64 v[16:19], v38 offset0:0 offset1:4
    ds_read2_b64 v[20:23], v38 offset0:8 offset1:12
    ds_read2_b64 v[24:27], v38 offset0:16 offset1:20
    ds_read2_b64 v[28:31], v38 offset0:24 offset1:28
    s_waitcnt lgkmcnt(3)
    v_mfma_f32_16x16x32_bf16 v[8:11], v[16:19], v[40:43], 0
    s_waitcnt lgkmcnt(2)
    v_mfma_f32_16x16x32_bf16 v[8:11], v[20:23], v[44:47], v[8:11]
    s_waitcnt lgkmcnt(1)
    v_mfma_f32_16x16x32_bf16 v[8:11], v[24:27], v[48:51], v[8:11]
    s_waitcnt lgkmcnt(0)
    v_mfma_f32_16x16x32_bf16 v[8:11], v[28:31], v[52:55], v[8:11]
    s_mov_b64 exec, 0xffff
    s_nop 6
    buffer_store_dwordx4 v[8:11], v35, s[36:39], s57 offen sc1
    s_mov_b64 exec, -1
    s_cmp_lg_u32 s45, 0
    s_cbranch_scc1 L_fin
    s_lshl_b32 s52, s64, 16
    s_lshl_b32 s53, s46, 8
    s_add_u32 s52, s52, s53
    s_add_u32 s52, s52, 196608
    s_add_u32 s53, s52, 32768
    v_lshlrev_b32 v12, 13, v5
    v_lshl_add_u32 v12, v6, 4, v12
    s_mov_b32 s65, 0
L_poll7_y:
    buffer_load_dwordx4 v[16:19], v12, s[36:39], s52 offen sc1
    buffer_load_dwordx4 v[20:23], v12, s[36:39], s53 offen sc1
    s_waitcnt vmcnt(0)
    v_cmp_eq_u32 vcc, -1, v16
    v_cmp_eq_u32 s[54:55], -1, v17
    s_nop 0
    s_or_b64 vcc, vcc, s[54:55]
    v_cmp_eq_u32 s[54:55], -1, v18
    s_nop 0
    s_or_b64 vcc, vcc, s[54:55]
    v_cmp_eq_u32 s[54:55], -1, v19
    s_nop 0
    s_or_b64 vcc, vcc, s[54:55]
    v_cmp_eq_u32 s[54:55], -1, v20
    s_nop 0
    s_or_b64 vcc, vcc, s[54:55]
    v_cmp_eq_u32 s[54:55], -1, v21
    s_nop 0
    s_or_b64 vcc, vcc, s[54:55]
    v_cmp_eq_u32 s[54:55], -1, v22
    s_nop 0
    s_or_b64 vcc, vcc, s[54:55]
    v_cmp_eq_u32 s[54:55], -1, v23
    s_nop 0
    s_or_b64 vcc, vcc, s[54:55]
    s_add_u32 s65, s65, 1
    s_cmp_gt_u32 s65, 40000
    s_cbranch_scc1 L_poll7_y_x
    s_cmp_lg_u64 vcc, 0
    s_cbranch_scc1 L_poll7_y
L_poll7_y_x:
    v_add_f32 v16, v16, v20
    v_add_f32 v17, v17, v21
    v_add_f32 v18, v18, v22
    v_add_f32 v19, v19, v23
    v_permlane16_swap_b32 v16, v17
    s_nop 0
    v_permlane16_swap_b32 v18, v19
    v_add_f32 v16, v16, v17
    v_add_f32 v18, v18, v19
    s_nop 1
    v_permlane32_swap_b32 v16, v18
    v_add_f32 v16, v16, v18
    s_lshl_b32 s52, s64, 8
    v_lshlrev_b32 v12, 2, v1
    v_add_u32 v13, s52, v12
    ds_write_b32 v13, v16 offset:24832
    s_waitcnt lgkmcnt(0)
    s_barrier
    s_cmp_lg_u32 s64, 0
    s_cbranch_scc1 L_not2
    ds_read_b32 v16, v12 offset:24832
    ds_read_b32 v17, v12 offset:25088
    ds_read_b32 v18, v12 offset:25344
    ds_read_b32 v19, v12 offset:25600
    v_lshlrev_b32 v24, 16, v63
    v_lshlrev_b32 v12, 10, v5
    v_lshl_add_u32 v12, v6, 1, v12
    s_lshl_b32 s52, s46, 5
    s_add_u32 s52, s52, 458752
    s_waitcnt lgkmcnt(0)
    v_add_f32 v16, v16, v17
    v_add_f32 v18, v18, v19
    v_add_f32 v16, v16, v18
    v_cvt_pk_bf16_f32 v16, v16, v16
    v_lshlrev_b32 v16, 16, v16
    v_add_f32 v16, v16, v24
    s_nop 1
    v_mov_b32_dpp v17, v16 quad_perm:[1,0,3,2] row_mask:0xf bank_mask:0xf
    v_cvt_pk_bf16_f32 v16, v16, v17
    v_lshlrev_b32 v62, 16, v16
    s_mov_b32 exec_lo, 0x55555555
    s_mov_b32 exec_hi, 0x55555555
    s_cmp_eq_u32 s70, 1
    s_cbranch_scc1 L_ls8
    buffer_store_dword v16, v12, s[36:39], s52 offen sc1
    s_branch L_le8
L_ls8:
    s_nop 3
    buffer_store_dword v16, v12, s[36:39], s52 offen
L_le8:
    s_mov_b64 exec, -1
L_not2:
    s_lshl_b32 s52, s64, 10
    s_add_u32 s52, s52, 458752
    v_mov_b32 v12, v2
    s_cmp_ge_u32 s46, 28
    s_cbranch_scc1 L_t4
    s_mov_b32 s65, 0
L_poll9_h:
    buffer_load_dwordx4 v[8:11], v12, s[36:39], s52 offen sc1
    s_waitcnt vmcnt(0)
    v_cmp_eq_u32 vcc, -1, v8
    v_cmp_eq_u32 s[54:55], -1, v9
    s_nop 0
    s_or_b64 vcc, vcc, s[54:55]
    v_cmp_eq_u32 s[54:55], -1, v10
    s_nop 0
    s_or_b64 vcc, vcc, s[54:55]
    v_cmp_eq_u32 s[54:55], -1, v11
    s_nop 0
    s_or_b64 vcc, vcc, s[54:55]
    s_add_u32 s65, s65, 1
    s_cmp_gt_u32 s65, 40000
    s_cbranch_scc1 L_poll9_h_x
    s_cmp_lg_u64 vcc, 0
    s_cbranch_scc1 L_poll9_h
L_poll9_h_x:
    v_lshlrev_b32 v16, 16, v8
    v_and_b32 v17, s61, v8
    v_lshlrev_b32 v18, 16, v9
    v_and_b32 v19, s61, v9
    v_lshlrev_b32 v20, 16, v10
    v_and_b32 v21, s61, v10
    v_lshlrev_b32 v22, 16, v11
    v_and_b32 v23, s61, v11
    v_add_f32 v24, v16, v17
    v_add_f32 v24, v24, v18
    v_add_f32 v24, v24, v19
    v_add_f32 v24, v24, v20
    v_add_f32 v24, v24, v21
    v_add_f32 v24, v24, v22
    v_add_f32 v24, v24, v23
    s_nop 1
    v_add_f32_dpp v24, v24, v24 row_ror:8 row_mask:0xf bank_mask:0xf
    s_nop 1
    v_add_f32_dpp v24, v24, v24 row_ror:4 row_mask:0xf bank_mask:0xf
    s_nop 1
    v_add_f32_dpp v24, v24, v24 row_ror:2 row_mask:0xf bank_mask:0xf
    s_nop 1
    v_add_f32_dpp v24, v24, v24 row_ror:1 row_mask:0xf bank_mask:0xf
    v_mov_b32 v25, v24
    s_nop 1
    v_permlane16_swap_b32 v24, v25
    v_add_f32 v24, v24, v25
    v_mov_b32 v25, v24
    s_nop 1
    v_permlane32_swap_b32 v24, v25
    v_add_f32 v24, v24, v25
    v_mul_f32 v24, 0x3b000000, v24
    v_sub_f32 v25, v16, v24
    v_mul_f32 v26, v25, v25
    v_sub_f32 v25, v17, v24
    v_fmac_f32 v26, v25, v25
    v_sub_f32 v25, v18, v24
    v_fmac_f32 v26, v25, v25
    v_sub_f32 v25, v19, v24
    v_fmac_f32 v26, v25, v25
    v_sub_f32 v25, v20, v24
    v_fmac_f32 v26, v25, v25
    v_sub_f32 v25, v21, v24
    v_fmac_f32 v26, v25, v25
    v_sub_f32 v25, v22, v24
    v_fmac_f32 v26, v25, v25
    v_sub_f32 v25, v23, v24
    v_fmac_f32 v26, v25, v25
    s_nop 1
    v_add_f32_dpp v26, v26, v26 row_ror:8 row_mask:0xf bank_mask:0xf
    s_nop 1
    v_add_f32_dpp v26, v26, v26 row_ror:4 row_mask:0xf bank_mask:0xf
    s_nop 1
    v_add_f32_dpp v26, v26, v26 row_ror:2 row_mask:0xf bank_mask:0xf
    s_nop 1
    v_add_f32_dpp v26, v26, v26 row_ror:1 row_mask:0xf bank_mask:0xf
    v_mov_b32 v25, v26
    s_nop 1
    v_permlane16_swap_b32 v26, v25
    v_add_f32 v26, v26, v25
    v_mov_b32 v25, v26
    s_nop 1
    v_permlane32_swap_b32 v26, v25
    v_add_f32 v26, v26, v25
    v_mul_f32 v26, 0x3b000000, v26
    v_cvt_pk_bf16_f32 v24, v24, v24
    v_lshlrev_b32 v24, 16, v24
    v_cvt_pk_bf16_f32 v26, v26, v26
    v_lshlrev_b32 v26, 16, v26
    v_add_f32 v26, 0x3727c5ac, v26
    v_cvt_pk_bf16_f32 v26, v26, v26
    v_lshlrev_b32 v26, 16, v26
    v_sqrt_f32 v26, v26
    s_nop 0
    v_cvt_pk_bf16_f32 v26, v26, v26
    v_lshlrev_b32 v26, 16, v26
    v_rcp_f32 v27, v26
    v_sub_f32 v16, v16, v24
    v_sub_f32 v17, v17, v24
    v_cvt_pk_bf16_f32 v25, v16, v17
    v_lshlrev_b32 v16, 16, v25
    v_and_b32 v17, s61, v25
    v_sub_f32 v18, v18, v24
    v_sub_f32 v19, v19, v24
    v_cvt_pk_bf16_f32 v25, v18, v19
    v_lshlrev_b32 v18, 16, v25
    v_and_b32 v19, s61, v25
    v_sub_f32 v20, v20, v24
    v_sub_f32 v21, v21, v24
    v_cvt_pk_bf16_f32 v25, v20, v21
    v_lshlrev_b32 v20, 16, v25
    v_and_b32 v21, s61, v25
    v_sub_f32 v22, v22, v24
    v_sub_f32 v23, v23, v24
    v_cvt_pk_bf16_f32 v25, v22, v23
    v_lshlrev_b32 v22, 16, v25
    v_and_b32 v23, s61, v25
    v_mul_f32 v28, v16, v27
    v_fma_f32 v29, -v28, v26, v16
    v_fma_f32 v16, v29, v27, v28
    v_mul_f32 v28, v17, v27
    v_fma_f32 v29, -v28, v26, v17
    v_fma_f32 v17, v29, v27, v28
    v_mul_f32 v28, v18, v27
    v_fma_f32 v29, -v28, v26, v18
    v_fma_f32 v18, v29, v27, v28
    v_mul_f32 v28, v19, v27
    v_fma_f32 v29, -v28, v26, v19
    v_fma_f32 v19, v29, v27, v28
    v_mul_f32 v28, v20, v27
    v_fma_f32 v29, -v28, v26, v20
    v_fma_f32 v20, v29, v27, v28
    v_mul_f32 v28, v21, v27
    v_fma_f32 v29, -v28, v26, v21
    v_fma_f32 v21, v29, v27, v28
    v_mul_f32 v28, v22, v27
    v_fma_f32 v29, -v28, v26, v22
    v_fma_f32 v22, v29, v27, v28
    v_mul_f32 v28, v23, v27
    v_fma_f32 v29, -v28, v26, v23
    v_fma_f32 v23, v29, v27, v28
    v_cvt_pk_bf16_f32 v8, v16, v17
    v_cvt_pk_bf16_f32 v9, v18, v19
    v_cvt_pk_bf16_f32 v10, v20, v21
    v_cvt_pk_bf16_f32 v11, v22, v23
    v_lshlrev_b32 v16, 16, v8
    v_and_b32 v17, s61, v8
    v_lshlrev_b32 v18, 16, v9
    v_and_b32 v19, s61, v9
    v_lshlrev_b32 v20, 16, v10
    v_and_b32 v21, s61, v10
    v_lshlrev_b32 v22, 16, v11
    v_and_b32 v23, s61, v11
    s_mul_i32 s52, s64, 1088
    v_add_u32 v12, s52, v2
    ds_write_b128 v12, v[8:11] offset:28160
    v_and_b32 v13, 3, v6
    v_mul_u32_u24 v57, 144, v13
    v_lshl_add_u32 v57, v5, 3, v57
    v_add_u32 v57, 8192, v57
    v_mul_u32_u24 v13, 1088, v13
    v_lshl_add_u32 v13, v5, 3, v13
    s_lshl_b32 s52, s64, 8
    s_add_u32 s52, s52, 28160
    v_add_u32 v56, s52, v13
    s_waitcnt lgkmcnt(0)
    s_barrier
    ds_read2_b64 v[8:11], v56 offset0:0 offset1:4
    ds_read2_b64 v[12:15], v56 offset0:8 offset1:12
    ds_read2_b64 v[16:19], v56 offset0:16 offset1:20
    ds_read2_b64 v[20:23], v56 offset0:24 offset1:28
    s_waitcnt lgkmcnt(3)
    v_mfma_f32_16x16x32_bf16 v[24:27], v[8:11], v[128:131], 0
    v_mfma_f32_16x16x32_bf16 v[28:31], v[8:11], v[132:135], 0
    v_mfma_f32_16x16x32_bf16 v[32:35], v[8:11], v[136:139], 0
    v_mfma_f32_16x16x32_bf16 v[36:39], v[8:11], v[140:143], 0
    v_mfma_f32_16x16x32_bf16 v[40:43], v[8:11], v[192:195], 0
    v_mfma_f32_16x16x32_bf16 v[44:47], v[8:11], v[196:199], 0
    v_mfma_f32_16x16x32_bf16 v[48:51], v[8:11], v[200:203], 0
    v_mfma_f32_16x16x32_bf16 v[52:55], v[8:11], v[204:207], 0
    s_waitcnt lgkmcnt(2)
    v_mfma_f32_16x16x32_bf16 v[24:27], v[12:15], v[144:147], v[24:27]
    v_mfma_f32_16x16x32_bf16 v[28:31], v[12:15], v[148:151], v[28:31]
    v_mfma_f32_16x16x32_bf16 v[32:35], v[12:15], v[152:155], v[32:35]
    v_mfma_f32_16x16x32_bf16 v[36:39], v[12:15], v[156:159], v[36:39]
    v_mfma_f32_16x16x32_bf16 v[40:43], v[12:15], v[208:211], v[40:43]
    v_mfma_f32_16x16x32_bf16 v[44:47], v[12:15], v[212:215], v[44:47]
    v_mfma_f32_16x16x32_bf16 v[48:51], v[12:15], v[216:219], v[48:51]
    v_mfma_f32_16x16x32_bf16 v[52:55], v[12:15], v[220:223], v[52:55]
    s_waitcnt lgkmcnt(1)
    v_mfma_f32_16x16x32_bf16 v[24:27], v[16:19], v[160:163], v[24:27]
    v_mfma_f32_16x16x32_bf16 v[28:31], v[16:19], v[164:167], v[28:31]
    v_mfma_f32_16x16x32_bf16 v[32:35], v[16:19], v[168:171], v[32:35]
    v_mfma_f32_16x16x32_bf16 v[36:39], v[16:19], v[172:175], v[36:39]
    v_mfma_f32_16x16x32_bf16 v[40:43], v[16:19], v[224:227], v[40:43]
    v_mfma_f32_16x16x32_bf16 v[44:47], v[16:19], v[228:231], v[44:47]
    v_mfma_f32_16x16x32_bf16 v[48:51], v[16:19], v[232:235], v[48:51]
    v_mfma_f32_16x16x32_bf16 v[52:55], v[16:19], v[236:239], v[52:55]
    s_waitcnt lgkmcnt(0)
    v_mfma_f32_16x16x32_bf16 v[24:27], v[20:23], v[176:179], v[24:27]
    v_mfma_f32_16x16x32_bf16 v[28:31], v[20:23], v[180:183], v[28:31]
    v_mfma_f32_16x16x32_bf16 v[32:35], v[20:23], v[184:187], v[32:35]
    v_mfma_f32_16x16x32_bf16 v[36:39], v[20:23], v[188:191], v[36:39]
    v_mfma_f32_16x16x32_bf16 v[40:43], v[20:23], v[240:243], v[40:43]
    v_mfma_f32_16x16x32_bf16 v[44:47], v[20:23], v[244:247], v[44:47]
    v_mfma_f32_16x16x32_bf16 v[48:51], v[20:23], v[248:251], v[48:51]
    v_mfma_f32_16x16x32_bf16 v[52:55], v[20:23], v[252:255], v[52:55]
    s_lshl_b32 s52, s64, 11
    v_lshlrev_b32 v12, 4, v6
    v_add_u32 v12, s52, v12
    s_mov_b64 exec, 0xffff
    ds_write_b128 v12, v[24:27] offset:0
    ds_write_b128 v12, v[28:31] offset:256
    ds_write_b128 v12, v[32:35] offset:512
    ds_write_b128 v12, v[36:39] offset:768
    ds_write_b128 v12, v[40:43] offset:1024
    ds_write_b128 v12, v[44:47] offset:1280
    ds_write_b128 v12, v[48:51] offset:1536
    ds_write_b128 v12, v[52:55] offset:1792
    s_mov_b64 exec, -1
    s_lshl_b32 s52, s64, 2
    v_add_u32 v12, s52, v2
    s_mul_i32 s53, s64, 144
    v_lshlrev_b32 v13, 1, v1
    v_add_u32 v13, s53, v13
    s_waitcnt lgkmcnt(0)
    s_barrier
    ds_read_b32 v16, v12 offset:0
    ds_read_b32 v20, v12 offset:1024
    ds_read_b32 v17, v12 offset:2048
    ds_read_b32 v21, v12 offset:3072
    ds_read_b32 v18, v12 offset:4096
    ds_read_b32 v22, v12 offset:5120
    ds_read_b32 v19, v12 offset:6144
    ds_read_b32 v23, v12 offset:7168
    s_waitcnt lgkmcnt(0)
    v_add_f32 v16, v16, v17
    v_add_f32 v18, v18, v19
    v_add_f32 v20, v20, v21
    v_add_f32 v22, v22, v23
    v_add_f32 v16, v16, v18
    v_add_f32 v20, v20, v22
    v_cvt_pk_bf16_f32 v16, v16, v20
    v_lshlrev_b32 v17, 16, v16
    v_and_b32 v18, s61, v16
    v_mul_f32 v17, 0xbfb8aa3b, v17
    v_min_f32 v17, 0x42fc0000, v17
    v_exp_f32 v17, v17
    s_nop 0
    v_add_f32 v17, 1.0, v17
    v_rcp_f32 v19, v17
    s_nop 0
    v_fma_f32 v17, -v17, v19, 1.0
    v_fma_f32 v17, v17, v19, v19
    v_cvt_pk_bf16_f32 v17, v17, v17
    v_lshlrev_b32 v17, 16, v17
    v_mul_f32 v17, v17, v18
    v_cvt_pk_bf16_f32 v17, v17, v17
    ds_write_b16 v13, v17 offset:8192
    s_waitcnt lgkmcnt(0)
    s_barrier
    ds_read2_b64 v[8:11], v57 offset0:0 offset1:4
    ds_read2_b64 v[12:15], v57 offset0:8 offset1:12
    s_waitcnt lgkmcnt(1)
    v_mfma_f32_16x16x32_bf16 v[24:27], v[8:11], v[64:67], 0
    v_mfma_f32_16x16x32_bf16 v[28:31], v[8:11], v[68:71], 0
    v_mfma_f32_16x16x32_bf16 v[32:35], v[8:11], v[72:75], 0
    v_mfma_f32_16x16x32_bf16 v[36:39], v[8:11], v[76:79], 0
    v_mfma_f32_16x16x32_bf16 v[40:43], v[8:11], v[80:83], 0
    v_mfma_f32_16x16x32_bf16 v[44:47], v[8:11], v[84:87], 0
    v_mfma_f32_16x16x32_bf16 v[48:51], v[8:11], v[88:91], 0
    v_mfma_f32_16x16x32_bf16 v[52:55], v[8:11], v[92:95], 0
    s_waitcnt lgkmcnt(0)
    v_mfma_f32_16x16x32_bf16 v[24:27], v[12:15], v[96:99], v[24:27]
    v_mfma_f32_16x16x32_bf16 v[28:31], v[12:15], v[100:103], v[28:31]
    v_mfma_f32_16x16x32_bf16 v[32:35], v[12:15], v[104:107], v[32:35]
    v_mfma_f32_16x16x32_bf16 v[36:39], v[12:15], v[108:111], v[36:39]
    v_mfma_f32_16x16x32_bf16 v[40:43], v[12:15], v[112:115], v[40:43]
    v_mfma_f32_16x16x32_bf16 v[44:47], v[12:15], v[116:119], v[44:47]
    v_mfma_f32_16x16x32_bf16 v[48:51], v[12:15], v[120:123], v[48:51]
    v_mfma_f32_16x16x32_bf16 v[52:55], v[12:15], v[124:127], v[52:55]
    s_lshl_b32 s52, s46, 13
    s_lshl_b32 s53, s64, 11
    s_add_u32 s52, s52, s53
    s_add_u32 s52, s52, 1572864
    v_lshlrev_b32 v12, 4, v6
    s_mov_b64 exec, 0xffff
    s_cmp_eq_u32 s70, 1
    s_cbranch_scc1 L_ls10
    buffer_store_dwordx4 v[24:27], v12, s[36:39], s52 offen offset:0 sc1
    buffer_store_dwordx4 v[28:31], v12, s[36:39], s52 offen offset:256 sc1
    buffer_store_dwordx4 v[32:35], v12, s[36:39], s52 offen offset:512 sc1
    buffer_store_dwordx4 v[36:39], v12, s[36:39], s52 offen offset:768 sc1
    buffer_store_dwordx4 v[40:43], v12, s[36:39], s52 offen offset:1024 sc1
    buffer_store_dwordx4 v[44:47], v12, s[36:39], s52 offen offset:1280 sc1
    buffer_store_dwordx4 v[48:51], v12, s[36:39], s52 offen offset:1536 sc1
    buffer_store_dwordx4 v[52:55], v12, s[36:39], s52 offen offset:1792 sc1
    s_branch L_le10
L_ls10:
    s_nop 3
    buffer_store_dwordx4 v[24:27], v12, s[36:39], s52 offen offset:0
    buffer_store_dwordx4 v[28:31], v12, s[36:39], s52 offen offset:256
    buffer_store_dwordx4 v[32:35], v12, s[36:39], s52 offen offset:512
    buffer_store_dwordx4 v[36:39], v12, s[36:39], s52 offen offset:768
    buffer_store_dwordx4 v[40:43], v12, s[36:39], s52 offen offset:1024
    buffer_store_dwordx4 v[44:47], v12, s[36:39], s52 offen offset:1280
    buffer_store_dwordx4 v[48:51], v12, s[36:39], s52 offen offset:1536
    buffer_store_dwordx4 v[52:55], v12, s[36:39], s52 offen offset:1792
L_le10:
    s_mov_b64 exec, -1
L_t4:
    s_lshl_b32 s52, s64, 16
    s_lshl_b32 s53, s46, 8
    s_add_u32 s52, s52, s53
    s_add_u32 s52, s52, 1572864
    s_add_u32 s53, s52, 32768
    s_cmp_eq_u32 s64, 3
    s_cselect_b32 s53, s52, s53
    s_cselect_b32 s58, 0, 1.0
    v_lshlrev_b32 v12, 13, v5
    v_lshl_add_u32 v12, v6, 4, v12
    s_mov_b32 s65, 0
L_poll11_po:
    buffer_load_dwordx4 v[16:19], v12, s[36:39], s52 offen sc1
    buffer_load_dwordx4 v[20:23], v12, s[36:39], s53 offen sc1
    s_waitcnt vmcnt(0)
    v_cmp_eq_u32 vcc, -1, v16
    v_cmp_eq_u32 s[54:55], -1, v17
    s_nop 0
    s_or_b64 vcc, vcc, s[54:55]
    v_cmp_eq_u32 s[54:55], -1, v18
    s_nop 0
    s_or_b64 vcc, vcc, s[54:55]
    v_cmp_eq_u32 s[54:55], -1, v19
    s_nop 0
    s_or_b64 vcc, vcc, s[54:55]
    v_cmp_eq_u32 s[54:55], -1, v20
    s_nop 0
    s_or_b64 vcc, vcc, s[54:55]
    v_cmp_eq_u32 s[54:55], -1, v21
    s_nop 0
    s_or_b64 vcc, vcc, s[54:55]
    v_cmp_eq_u32 s[54:55], -1, v22
    s_nop 0
    s_or_b64 vcc, vcc, s[54:55]
    v_cmp_eq_u32 s[54:55], -1, v23
    s_nop 0
    s_or_b64 vcc, vcc, s[54:55]
    s_add_u32 s65, s65, 1
    s_cmp_gt_u32 s65, 40000
    s_cbranch_scc1 L_poll11_po_x
    s_cmp_lg_u64 vcc, 0
    s_cbranch_scc1 L_poll11_po
L_poll11_po_x:
    v_fma_f32 v16, v20, s58, v16
    v_fma_f32 v17, v21, s58, v17
    v_fma_f32 v18, v22, s58, v18
    v_fma_f32 v19, v23, s58, v19
    v_permlane16_swap_b32 v16, v17
    s_nop 0
    v_permlane16_swap_b32 v18, v19
    v_add_f32 v16, v16, v17
    v_add_f32 v18, v18, v19
    s_nop 1
    v_permlane32_swap_b32 v16, v18
    v_add_f32 v16, v16, v18
    s_lshl_b32 s52, s64, 8
    v_lshlrev_b32 v12, 2, v1
    v_add_u32 v13, s52, v12
    ds_write_b32 v13, v16 offset:25856
    v_lshlrev_b32 v13, 10, v5
    v_lshl_add_u32 v13, v6, 1, v13
    s_lshl_b32 s52, s46, 5
    v_add_u32 v13, s52, v13
    s_waitcnt lgkmcnt(0)
    s_barrier
    s_cmp_lg_u32 s64, 0
    s_cbranch_scc1 L_fin
    ds_read_b32 v16, v12 offset:25856
    ds_read_b32 v17, v12 offset:26112
    ds_read_b32 v18, v12 offset:26368
    ds_read_b32 v19, v12 offset:26624
    s_waitcnt lgkmcnt(0)
    v_add_f32 v16, v16, v17
    v_add_f32 v18, v18, v19
    v_add_f32 v16, v16, v18
    v_cvt_pk_bf16_f32 v16, v16, v16
    v_lshlrev_b32 v16, 16, v16
    v_add_f32 v16, v16, v62
    v_cvt_pk_bf16_f32 v16, v16, v16
    global_store_short v13, v16, s[22:23]
L_fin:
L_end:
    s_endpgm
.section .rodata,"a"
.p2align 6
.amdhsa_kernel sequential_preLN__mha_block_cached__glu_gated_glu__decode_kernel
  .amdhsa_next_free_vgpr 256
  .amdhsa_next_free_sgpr 102
  .amdhsa_accum_offset 256
  .amdhsa_group_segment_fixed_size 0
  .amdhsa_kernarg_size 96
  .amdhsa_float_denorm_mode_32 3
  .amdhsa_user_sgpr_count 2
  .amdhsa_user_sgpr_kernarg_segment_ptr 1
  .amdhsa_system_sgpr_workgroup_id_x 1
.end_amdhsa_kernel
```
